```python
import torch

def _softmax(x, axis=-1):
    return torch.softmax(x, dim=axis)
def _gelu(x):
    return torch.nn.functional.gelu(x, approximate="tanh")
def _silu(x):
    return torch.nn.functional.silu(x)
def _sigmoid(x):
    return torch.sigmoid(x)
def _layernorm(x, axis=-1, eps=1e-5):
    m = x.mean(dim=axis, keepdim=True)
    v = x.var(dim=axis, keepdim=True, unbiased=False)
    return (x - m) / torch.sqrt(v + eps)
def _scatter_add(tgt, idx, src, axis=0):
    return tgt.clone().index_add_(axis, idx, src)
def _segment_sum(src, seg, n):
    out = torch.zeros((n,) + src.shape[1:], dtype=src.dtype)
    return out.index_add_(0, seg, src)
def _pad(x, pw):
    flat = tuple(v for pair in reversed(pw) for v in pair)
    return torch.nn.functional.pad(x, flat)

kernel_name = 'gated_mix__compressed_kv_cla__swiglu_ffn__decode'

def setup_inputs():

    _w = (lambda a: (lambda t: t.to(torch.bfloat16) if t.is_floating_point() else t)(torch.as_tensor(a)))
    def _A_setup():
        B, H, Sq, Sk, D, M = 2, 32, 1, 4096, 128, 640
        Dc = 4 * D
        return {
            "x": _w((lambda *s: torch.randn(*s, dtype=torch.bfloat16) * 0.05)(B, Sq, M)),
            "c_kv": _w((lambda *s: torch.randn(*s, dtype=torch.bfloat16) * 0.8)(B, Sk, Dc)),
            "w_q": _w((lambda *s: torch.randn(*s, dtype=torch.bfloat16) * 6.4)(M, H, D) * (M ** -0.5)),
            "w_uk": _w((lambda *s: torch.randn(*s, dtype=torch.bfloat16) * 6.4)(Dc, H, D) * (Dc ** -0.5)),
            "w_uv": _w((lambda *s: torch.randn(*s, dtype=torch.bfloat16) * 0.8)(Dc, H, D) * (Dc ** -0.5)),
            "w_o": _w((lambda *s: torch.randn(*s, dtype=torch.bfloat16) * 0.8)(H, D, M) * ((H * D) ** -0.5)),
        }
    _A_in = _A_setup()

    def _B_setup():
        B, S, D, F = 2, 1, 640, 1728
        return {
            "x": _w((lambda *s: torch.randn(*s, dtype=torch.bfloat16) * 0.05)(B, S, D)),
            "w_gate": _w((lambda *s: torch.randn(*s, dtype=torch.bfloat16) * 0.1)(D, F)),
            "w_up": _w((lambda *s: torch.randn(*s, dtype=torch.bfloat16) * 0.1)(D, F)),
            "w_down": _w((lambda *s: torch.randn(*s, dtype=torch.bfloat16) * 0.1)(F, D)),
        }
    _B_in = _B_setup()

    return {
        "A_x": _A_in["x"],
        "A_c_kv": _A_in["c_kv"],
        "A_w_q": _A_in["w_q"],
        "A_w_uk": _A_in["w_uk"],
        "A_w_uv": _A_in["w_uv"],
        "A_w_o": _A_in["w_o"],
        "B_x": _B_in["x"],
        "B_w_gate": _B_in["w_gate"],
        "B_w_up": _B_in["w_up"],
        "B_w_down": _B_in["w_down"],
        "gate_w": _w((lambda *s: torch.randn(*s, dtype=torch.bfloat16) * 0.1)(640) * 16.0),
    }

def reference(A_x, A_c_kv, A_w_q, A_w_uk, A_w_uv, A_w_o, B_x, B_w_gate, B_w_up, B_w_down, gate_w):
    def _A_ref(x, c_kv, w_q, w_uk, w_uv, w_o):
        B, Sq, M = x.shape[0], x.shape[1], x.shape[2]
        Sk = c_kv.shape[1]
        H, D = w_q.shape[1], w_q.shape[2]
        q = torch.einsum("bqm,mhd->bhqd", x, w_q)
        k = torch.einsum("bkc,chd->bhkd", c_kv, w_uk)
        v = torch.einsum("bkc,chd->bhkd", c_kv, w_uv)
        scores = torch.einsum("bhqd,bhkd->bhqk", q, k) * (D ** -0.5)
        off = Sk - Sq
        qi = torch.arange(Sq)[:, None]
        kj = torch.arange(Sk)[None, :]
        cmask = kj <= (qi + off)
        scores = torch.where(cmask[None, None], scores, -1e9)
        p = _softmax(scores, axis=-1)
        ctx = torch.einsum("bhqk,bhkd->bhqd", p, v)
        return torch.einsum("bhqd,hdm->bqm", ctx, w_o)

    def _B_ref(x, w_gate, w_up, w_down):
        g = _silu(x @ w_gate)
        u = x @ w_up
        return (g * u) @ w_down

    x = A_x
    g = _sigmoid((x * gate_w).sum(-1, keepdims=True))
    a = _A_ref(x, A_c_kv, A_w_q, A_w_uk, A_w_uv, A_w_o)
    b = _B_ref(x, B_w_gate, B_w_up, B_w_down)
    return g * a + (1 - g) * b
```

```asm
; @launch grid=(256,1,1) block=(512,1,1) lds=131136
.amdgcn_target "amdgcn-amd-amdhsa--gfx950"
.text
.globl gated_mix__compressed_kv_cla__swiglu_ffn__decode_kernel
.p2align 8
.type gated_mix__compressed_kv_cla__swiglu_ffn__decode_kernel,@function
gated_mix__compressed_kv_cla__swiglu_ffn__decode_kernel:
    s_load_dwordx16 s[16:31], s[0:1], 0
    s_load_dwordx8 s[32:39], s[0:1], 64
    s_load_dwordx4 s[40:43], s[0:1], 96
    s_cmp_ge_u32 s2, 256
    s_cbranch_scc1 L_end
    v_lshrrev_b32 v1, 6, v0
    v_and_b32 v0, 63, v0
    s_and_b32 s4, s2, 7
    v_readfirstlane_b32 s8, v1
    s_movk_i32 s48, 0xfff
    v_and_b32 v1, 15, v0
    v_lshrrev_b32 v2, 4, v0
    s_cmp_lg_u32 s8, 3
    s_cbranch_scc1 nocpf_1
    s_getpc_b64 s[12:13]
L_pc:
    s_lshr_b32 s10, s2, 3
    s_and_b32 s10, s10, 15
    s_lshl_b32 s10, s10, 10
    v_lshlrev_b32 v3, 4, v0
    v_add_u32 v3, s10, v3
    v_min_u32 v3, L_end-L_pc-16, v3
    global_load_dwordx4 v[252:255], v3, s[12:13]
    s_nop 0
nocpf_1:
    s_cmp_ge_u32 s2, 128
    s_cbranch_scc1 L_A
    s_bfe_u32 s5, s2, 0x20003
    s_lshr_b32 s7, s2, 5
    s_lshl_b32 s7, s7, 3
    s_add_u32 s7, s7, s4
    s_lshl_b32 s14, s5, 1
    s_add_u32 s14, s14, s8
    v_xor_b32 v13, v1, v2
    v_lshlrev_b32 v3, 13, v2
    v_lshl_add_u32 v3, v13, 4, v3
    s_sub_u32 s51, s8, 4
    s_max_i32 s51, s51, 0
    s_lshl_b32 s62, s51, 13
    s_add_u32 s62, s62, 0x2000
    s_mov_b32 m0, s62
    s_waitcnt lgkmcnt(0)
    s_load_dword s9, s[42:43], 0
    s_cmp_lt_u32 s8, 4
    s_cbranch_scc1 nouk_2
    s_lshl_b32 s10, s5, 20
    s_lshl_b32 s11, s51, 18
    s_add_u32 s10, s10, s11
    s_lshl_b32 s11, s7, 8
    s_add_u32 s10, s10, s11
    s_add_u32 s12, s22, s10
    s_addc_u32 s13, s23, 0
    v_xor_b32 v13, 0, v3
    global_load_lds_dwordx4 v13, s[12:13] offset:0 nt
    v_xor_b32 v13, 64, v3
    v_add_u32 v13, 31744, v13
    global_load_lds_dwordx4 v13, s[12:13] offset:1024 nt
    v_xor_b32 v13, 128, v3
    v_add_u32 v13, 63488, v13
    global_load_lds_dwordx4 v13, s[12:13] offset:2048 nt
    v_xor_b32 v13, 192, v3
    v_add_u32 v13, 95232, v13
    global_load_lds_dwordx4 v13, s[12:13] offset:3072 nt
    v_xor_b32 v13, 0, v3
    v_add_u32 v13, 131072, v13
    s_add_u32 m0, m0, 4096
    s_nop 0
    global_load_lds_dwordx4 v13, s[12:13] offset:0 nt
    v_xor_b32 v13, 64, v3
    v_add_u32 v13, 162816, v13
    global_load_lds_dwordx4 v13, s[12:13] offset:1024 nt
    v_xor_b32 v13, 128, v3
    v_add_u32 v13, 194560, v13
    global_load_lds_dwordx4 v13, s[12:13] offset:2048 nt
    v_xor_b32 v13, 192, v3
    v_add_u32 v13, 226304, v13
    global_load_lds_dwordx4 v13, s[12:13] offset:3072 nt
    s_nop 0
nouk_2:
    v_mov_b32 v232, s30
    v_mov_b32 v233, s31
    v_mov_b32 v234, s32
    v_mov_b32 v235, s33
    v_cmp_lt_u32 vcc, 7, v1
    s_nop 1
    v_cndmask_b32 v232, v232, v234, vcc
    v_cndmask_b32 v233, v233, v235, vcc
    s_mov_b32 s10, 69120
    v_mul_lo_u32 v234, v2, s10
    v_and_b32 v235, 7, v0
    v_lshl_add_u32 v234, v235, 4, v234
    s_mul_i32 s10, s14, 276480
    s_lshl_b32 s11, s7, 7
    s_add_u32 s10, s10, s11
    v_add_u32 v234, s10, v234
    v_add_co_u32 v232, vcc, v232, v234
    s_nop 1
    v_addc_co_u32 v233, vcc, 0, v233, vcc
    s_cmp_lt_u32 s7, 27
    s_cselect_b32 s59, s8, 9
    s_barrier
    s_cmp_ge_u32 s59, 2
    s_cbranch_scc1 L_F_noffn1
    s_sleep 8
    v_bfe_u32 v126, v0, 3, 1
    v_mul_u32_u24 v126, 1280, v126
    v_mul_u32_u24 v127, 40, v2
    v_add_u32 v126, v126, v127
    s_mul_i32 s10, s14, 160
    s_add_u32 s12, s16, s10
    s_addc_u32 s13, s17, 0
    global_load_dwordx4 v[112:115], v126, s[12:13]
    global_load_dwordx4 v[116:119], v126, s[12:13] offset:16
    global_load_dwordx2 v[120:121], v126, s[12:13] offset:32
    global_load_dwordx4 v[32:35], v[232:233], off nt
    v_add_co_u32 v232, vcc, 3456, v232
    s_nop 1
    v_addc_co_u32 v233, vcc, 0, v233, vcc
    global_load_dwordx4 v[36:39], v[232:233], off nt
    v_add_co_u32 v232, vcc, 3456, v232
    s_nop 1
    v_addc_co_u32 v233, vcc, 0, v233, vcc
    global_load_dwordx4 v[40:43], v[232:233], off nt
    v_add_co_u32 v232, vcc, 3456, v232
    s_nop 1
    v_addc_co_u32 v233, vcc, 0, v233, vcc
    global_load_dwordx4 v[44:47], v[232:233], off nt
    v_add_co_u32 v232, vcc, 3456, v232
    s_nop 1
    v_addc_co_u32 v233, vcc, 0, v233, vcc
    global_load_dwordx4 v[48:51], v[232:233], off nt
    v_add_co_u32 v232, vcc, 3456, v232
    s_nop 1
    v_addc_co_u32 v233, vcc, 0, v233, vcc
    global_load_dwordx4 v[52:55], v[232:233], off nt
    v_add_co_u32 v232, vcc, 3456, v232
    s_nop 1
    v_addc_co_u32 v233, vcc, 0, v233, vcc
    global_load_dwordx4 v[56:59], v[232:233], off nt
    v_add_co_u32 v232, vcc, 3456, v232
    s_nop 1
    v_addc_co_u32 v233, vcc, 0, v233, vcc
    global_load_dwordx4 v[60:63], v[232:233], off nt
    v_add_co_u32 v232, vcc, 3456, v232
    s_nop 1
    v_addc_co_u32 v233, vcc, 0, v233, vcc
    global_load_dwordx4 v[64:67], v[232:233], off nt
    v_add_co_u32 v232, vcc, 3456, v232
    s_nop 1
    v_addc_co_u32 v233, vcc, 0, v233, vcc
    global_load_dwordx4 v[68:71], v[232:233], off nt
    v_add_co_u32 v232, vcc, 3456, v232
    s_nop 1
    v_addc_co_u32 v233, vcc, 0, v233, vcc
    global_load_dwordx4 v[72:75], v[232:233], off nt
    v_add_co_u32 v232, vcc, 3456, v232
    s_nop 1
    v_addc_co_u32 v233, vcc, 0, v233, vcc
    global_load_dwordx4 v[76:79], v[232:233], off nt
    v_add_co_u32 v232, vcc, 3456, v232
    s_nop 1
    v_addc_co_u32 v233, vcc, 0, v233, vcc
    global_load_dwordx4 v[80:83], v[232:233], off nt
    v_add_co_u32 v232, vcc, 3456, v232
    s_nop 1
    v_addc_co_u32 v233, vcc, 0, v233, vcc
    global_load_dwordx4 v[84:87], v[232:233], off nt
    v_add_co_u32 v232, vcc, 3456, v232
    s_nop 1
    v_addc_co_u32 v233, vcc, 0, v233, vcc
    global_load_dwordx4 v[88:91], v[232:233], off nt
    v_add_co_u32 v232, vcc, 3456, v232
    s_nop 1
    v_addc_co_u32 v233, vcc, 0, v233, vcc
    global_load_dwordx4 v[92:95], v[232:233], off nt
    v_add_co_u32 v232, vcc, 3456, v232
    s_nop 1
    v_addc_co_u32 v233, vcc, 0, v233, vcc
    global_load_dwordx4 v[96:99], v[232:233], off nt
    v_add_co_u32 v232, vcc, 3456, v232
    s_nop 1
    v_addc_co_u32 v233, vcc, 0, v233, vcc
    global_load_dwordx4 v[100:103], v[232:233], off nt
    v_add_co_u32 v232, vcc, 3456, v232
    s_nop 1
    v_addc_co_u32 v233, vcc, 0, v233, vcc
    global_load_dwordx4 v[104:107], v[232:233], off nt
    v_add_co_u32 v232, vcc, 3456, v232
    s_nop 1
    v_addc_co_u32 v233, vcc, 0, v233, vcc
    global_load_dwordx4 v[108:111], v[232:233], off nt
    s_nop 3
L_F_noffn1:
    v_mov_b32 v24, v232
    v_mov_b32 v25, v233
    s_mov_b32 s100, s14
    s_mov_b32 s101, s59
    v_and_b32 v211, 1, v0
    v_cmp_eq_u32 vcc, 1, v211
    v_mov_b32 v208, 0x0c0c0100
    v_mov_b32 v209, 0x01000c0c
    v_cndmask_b32 v208, v208, v209, vcc
    v_mov_b32 v209, 0x0c0c0302
    v_mov_b32 v210, 0x03020c0c
    v_cndmask_b32 v209, v209, v210, vcc
    v_bfe_u32 v211, v0, 1, 2
    v_mov_b32 v210, 0x0c0c0c0c
    v_cmp_eq_u32 vcc, 0, v211
    s_nop 1
    v_cndmask_b32 v4, v210, v208, vcc
    v_cndmask_b32 v8, v210, v209, vcc
    v_cmp_eq_u32 vcc, 1, v211
    s_nop 1
    v_cndmask_b32 v5, v210, v208, vcc
    v_cndmask_b32 v9, v210, v209, vcc
    v_cmp_eq_u32 vcc, 2, v211
    s_nop 1
    v_cndmask_b32 v6, v210, v208, vcc
    v_cndmask_b32 v10, v210, v209, vcc
    v_cmp_eq_u32 vcc, 3, v211
    s_nop 1
    v_cndmask_b32 v7, v210, v208, vcc
    v_cndmask_b32 v11, v210, v209, vcc
    s_waitcnt lgkmcnt(0)
    s_add_u32 s9, s9, 0x9e5
    s_and_b32 s44, s9, 0xfff
    s_add_u32 s45, s44, 0x155
    s_and_b32 s45, s45, 0xfff
    s_add_u32 s46, s44, 0x2aa
    s_and_b32 s46, s46, 0xfff
    s_add_u32 s47, s44, 0x3ff
    s_and_b32 s47, s47, 0xfff
    v_mov_b32 v12, 0xfffff000
    s_and_b32 s28, s9, 1
    s_mul_i32 s28, s28, 0x10001
    s_xor_b32 s29, s28, 1
    s_xor_b32 s40, s28, 0x10000
    s_xor_b32 s41, s28, 0x10001
    v_lshlrev_b32 v13, 4, v0
    s_lshl_b32 s10, s7, 13
    s_lshl_b32 s11, s8, 10
    s_add_u32 s10, s10, s11
    s_add_u32 s10, s10, 0x40000
    s_add_u32 s54, s42, s10
    s_addc_u32 s55, s43, 0
    v_lshrrev_b32 v14, 5, v0
    v_lshlrev_b32 v14, 3, v14
    v_add_u32 v14, s8, v14
    v_mul_u32_u24 v14, 272, v14
    v_and_b32 v15, 31, v0
    v_lshl_add_u32 v14, v15, 3, v14
    v_mul_u32_u24 v15, 272, v1
    v_lshl_add_u32 v15, v2, 4, v15
    v_bfe_u32 v3, v0, 3, 1
    v_lshlrev_b32 v3, 15, v3
    v_bfe_u32 v16, v0, 2, 1
    v_lshl_add_u32 v3, v16, 5, v3
    v_lshl_add_u32 v3, v2, 3, v3
    s_lshr_b32 s63, s7, 4
    s_and_b32 s15, s7, 15
    s_lshl_b32 s10, s63, 14
    s_lshl_b32 s11, s15, 6
    s_add_u32 s10, s10, s11
    s_lshl_b32 s11, s5, 12
    s_add_u32 s10, s10, s11
    s_lshl_b32 s11, s51, 10
    s_add_u32 s10, s10, s11
    s_add_u32 s10, s10, 0x20000
    s_add_u32 s60, s42, s10
    s_addc_u32 s61, s43, 0
    v_mov_b32 v16, 0x07060302
    v_mov_b32 v17, 0xfffefffe
    v_lshlrev_b32 v22, 1, v2
    v_and_b32 v22, 2, v22
    v_and_b32 v18, 1, v22
    v_lshrrev_b32 v23, 1, v22
    v_lshl_or_b32 v18, v23, 16, v18
    v_xor_b32 v18, s28, v18
    v_xor_b32 v19, 0x10001, v18
    v_or_b32 v22, 1, v22
    v_and_b32 v20, 1, v22
    v_lshrrev_b32 v23, 1, v22
    v_lshl_or_b32 v20, v23, 16, v20
    v_xor_b32 v20, s28, v20
    v_xor_b32 v21, 0x10001, v20
    s_cmp_ge_u32 s59, 2
    s_cbranch_scc1 L_F_h1
    s_lshl_b32 s10, s7, 13
    s_lshl_b32 s11, s14, 10
    s_add_u32 s10, s10, s11
    s_add_u32 s10, s10, 0xc0000
    s_add_u32 s56, s42, s10
    s_addc_u32 s57, s43, 0
    v_lshrrev_b32 v126, 5, v0
    v_lshlrev_b32 v126, 9, v126
    v_lshl_add_u32 v126, v1, 5, v126
    v_and_b32 v127, 1, v2
    v_lshl_add_u32 v126, v127, 4, v126
    s_waitcnt vmcnt(20)
    v_perm_b32 v128, v112, v112, v4
    v_perm_b32 v129, v112, v112, v5
    v_perm_b32 v130, v112, v112, v6
    v_perm_b32 v131, v112, v112, v7
    v_perm_b32 v132, v112, v112, v8
    v_perm_b32 v133, v112, v112, v9
    v_perm_b32 v134, v112, v112, v10
    v_perm_b32 v135, v112, v112, v11
    v_perm_b32 v136, v113, v113, v4
    v_perm_b32 v137, v113, v113, v5
    v_perm_b32 v138, v113, v113, v6
    v_perm_b32 v139, v113, v113, v7
    v_perm_b32 v140, v113, v113, v8
    v_perm_b32 v141, v113, v113, v9
    v_perm_b32 v142, v113, v113, v10
    v_perm_b32 v143, v113, v113, v11
    v_perm_b32 v144, v114, v114, v4
    v_perm_b32 v145, v114, v114, v5
    v_perm_b32 v146, v114, v114, v6
    v_perm_b32 v147, v114, v114, v7
    v_perm_b32 v148, v114, v114, v8
    v_perm_b32 v149, v114, v114, v9
    v_perm_b32 v150, v114, v114, v10
    v_perm_b32 v151, v114, v114, v11
    v_perm_b32 v152, v115, v115, v4
    v_perm_b32 v153, v115, v115, v5
    v_perm_b32 v154, v115, v115, v6
    v_perm_b32 v155, v115, v115, v7
    v_perm_b32 v156, v115, v115, v8
    v_perm_b32 v157, v115, v115, v9
    v_perm_b32 v158, v115, v115, v10
    v_perm_b32 v159, v115, v115, v11
    v_perm_b32 v160, v116, v116, v4
    v_perm_b32 v161, v116, v116, v5
    v_perm_b32 v162, v116, v116, v6
    v_perm_b32 v163, v116, v116, v7
    v_perm_b32 v164, v116, v116, v8
    v_perm_b32 v165, v116, v116, v9
    v_perm_b32 v166, v116, v116, v10
    v_perm_b32 v167, v116, v116, v11
    v_perm_b32 v168, v117, v117, v4
    v_perm_b32 v169, v117, v117, v5
    v_perm_b32 v170, v117, v117, v6
    v_perm_b32 v171, v117, v117, v7
    v_perm_b32 v172, v117, v117, v8
    v_perm_b32 v173, v117, v117, v9
    v_perm_b32 v174, v117, v117, v10
    v_perm_b32 v175, v117, v117, v11
    v_perm_b32 v176, v118, v118, v4
    v_perm_b32 v177, v118, v118, v5
    v_perm_b32 v178, v118, v118, v6
    v_perm_b32 v179, v118, v118, v7
    v_perm_b32 v180, v118, v118, v8
    v_perm_b32 v181, v118, v118, v9
    v_perm_b32 v182, v118, v118, v10
    v_perm_b32 v183, v118, v118, v11
    v_perm_b32 v184, v119, v119, v4
    v_perm_b32 v185, v119, v119, v5
    v_perm_b32 v186, v119, v119, v6
    v_perm_b32 v187, v119, v119, v7
    v_perm_b32 v188, v119, v119, v8
    v_perm_b32 v189, v119, v119, v9
    v_perm_b32 v190, v119, v119, v10
    v_perm_b32 v191, v119, v119, v11
    v_perm_b32 v192, v120, v120, v4
    v_perm_b32 v193, v120, v120, v5
    v_perm_b32 v194, v120, v120, v6
    v_perm_b32 v195, v120, v120, v7
    v_perm_b32 v196, v120, v120, v8
    v_perm_b32 v197, v120, v120, v9
    v_perm_b32 v198, v120, v120, v10
    v_perm_b32 v199, v120, v120, v11
    v_perm_b32 v200, v121, v121, v4
    v_perm_b32 v201, v121, v121, v5
    v_perm_b32 v202, v121, v121, v6
    v_perm_b32 v203, v121, v121, v7
    v_perm_b32 v204, v121, v121, v8
    v_perm_b32 v205, v121, v121, v9
    v_perm_b32 v206, v121, v121, v10
    v_perm_b32 v207, v121, v121, v11
    s_waitcnt vmcnt(19)
    v_mfma_f32_16x16x32_bf16 v[122:125], v[128:131], v[32:35], 0
    s_waitcnt vmcnt(18)
    v_mfma_f32_16x16x32_bf16 v[122:125], v[132:135], v[36:39], v[122:125]
    s_waitcnt vmcnt(17)
    v_mfma_f32_16x16x32_bf16 v[122:125], v[136:139], v[40:43], v[122:125]
    s_waitcnt vmcnt(16)
    v_mfma_f32_16x16x32_bf16 v[122:125], v[140:143], v[44:47], v[122:125]
    s_waitcnt vmcnt(15)
    v_mfma_f32_16x16x32_bf16 v[122:125], v[144:147], v[48:51], v[122:125]
    s_waitcnt vmcnt(14)
    v_mfma_f32_16x16x32_bf16 v[122:125], v[148:151], v[52:55], v[122:125]
    s_waitcnt vmcnt(13)
    v_mfma_f32_16x16x32_bf16 v[122:125], v[152:155], v[56:59], v[122:125]
    s_waitcnt vmcnt(12)
    v_mfma_f32_16x16x32_bf16 v[122:125], v[156:159], v[60:63], v[122:125]
    s_waitcnt vmcnt(11)
    v_mfma_f32_16x16x32_bf16 v[122:125], v[160:163], v[64:67], v[122:125]
    s_waitcnt vmcnt(10)
    v_mfma_f32_16x16x32_bf16 v[122:125], v[164:167], v[68:71], v[122:125]
    s_waitcnt vmcnt(9)
    v_mfma_f32_16x16x32_bf16 v[122:125], v[168:171], v[72:75], v[122:125]
    s_waitcnt vmcnt(8)
    v_mfma_f32_16x16x32_bf16 v[122:125], v[172:175], v[76:79], v[122:125]
    s_waitcnt vmcnt(7)
    v_mfma_f32_16x16x32_bf16 v[122:125], v[176:179], v[80:83], v[122:125]
    s_waitcnt vmcnt(6)
    v_mfma_f32_16x16x32_bf16 v[122:125], v[180:183], v[84:87], v[122:125]
    s_waitcnt vmcnt(5)
    v_mfma_f32_16x16x32_bf16 v[122:125], v[184:187], v[88:91], v[122:125]
    s_waitcnt vmcnt(4)
    v_mfma_f32_16x16x32_bf16 v[122:125], v[188:191], v[92:95], v[122:125]
    s_waitcnt vmcnt(3)
    v_mfma_f32_16x16x32_bf16 v[122:125], v[192:195], v[96:99], v[122:125]
    s_waitcnt vmcnt(2)
    v_mfma_f32_16x16x32_bf16 v[122:125], v[196:199], v[100:103], v[122:125]
    s_waitcnt vmcnt(1)
    v_mfma_f32_16x16x32_bf16 v[122:125], v[200:203], v[104:107], v[122:125]
    s_waitcnt vmcnt(0)
    v_mfma_f32_16x16x32_bf16 v[122:125], v[204:207], v[108:111], v[122:125]
    s_nop 7
    v_add_u32 v122, 0x800, v122
    v_add_u32 v123, 0x800, v123
    v_add_u32 v124, 0x800, v124
    v_add_u32 v125, 0x800, v125
    v_and_or_b32 v122, v122, v12, s44
    v_and_or_b32 v123, v123, v12, s45
    v_and_or_b32 v124, v124, v12, s46
    v_and_or_b32 v125, v125, v12, s47
    global_store_dwordx4 v126, v[122:125], s[56:57] sc1
    s_nop 1
L_F_h1:
    s_cmp_lg_u32 s8, 2
    s_cbranch_scc1 L_F_nogate
    v_lshlrev_b32 v56, 4, v0
    v_lshlrev_b32 v57, 4, v1
    global_load_dwordx4 v[32:35], v56, s[16:17]
    global_load_dwordx4 v[36:39], v57, s[16:17] offset:1024
    global_load_dwordx4 v[40:43], v56, s[16:17] offset:1280
    global_load_dwordx4 v[44:47], v57, s[16:17] offset:2304
    global_load_dwordx4 v[48:51], v56, s[36:37]
    global_load_dwordx4 v[52:55], v57, s[36:37] offset:1024
    v_mov_b32 v58, 0
    v_mov_b32 v59, 0
    v_cmp_lt_u32 vcc, 15, v0
    s_waitcnt vmcnt(0)
    s_nop 0
    v_cndmask_b32 v52, v52, v58, vcc
    v_cndmask_b32 v53, v53, v58, vcc
    v_cndmask_b32 v54, v54, v58, vcc
    v_cndmask_b32 v55, v55, v58, vcc
    v_dot2_f32_bf16 v58, v32, v48, v58
    v_dot2_f32_bf16 v58, v33, v49, v58
    v_dot2_f32_bf16 v58, v34, v50, v58
    v_dot2_f32_bf16 v58, v35, v51, v58
    v_dot2_f32_bf16 v58, v36, v52, v58
    v_dot2_f32_bf16 v58, v37, v53, v58
    v_dot2_f32_bf16 v58, v38, v54, v58
    v_dot2_f32_bf16 v58, v39, v55, v58
    v_dot2_f32_bf16 v59, v40, v48, v59
    v_dot2_f32_bf16 v59, v41, v49, v59
    v_dot2_f32_bf16 v59, v42, v50, v59
    v_dot2_f32_bf16 v59, v43, v51, v59
    v_dot2_f32_bf16 v59, v44, v52, v59
    v_dot2_f32_bf16 v59, v45, v53, v59
    v_dot2_f32_bf16 v59, v46, v54, v59
    v_dot2_f32_bf16 v59, v47, v55, v59
    v_add_f32_dpp v58, v58, v58 quad_perm:[1,0,3,2] row_mask:0xf bank_mask:0xf
    s_nop 1
    v_add_f32_dpp v58, v58, v58 quad_perm:[2,3,0,1] row_mask:0xf bank_mask:0xf
    s_nop 1
    v_add_f32_dpp v58, v58, v58 row_half_mirror row_mask:0xf bank_mask:0xf
    s_nop 1
    v_add_f32_dpp v58, v58, v58 row_mirror row_mask:0xf bank_mask:0xf
    v_mov_b32 v60, v58
    s_nop 1
    v_permlane16_swap_b32 v58, v60
    v_add_f32 v58, v58, v60
    v_mov_b32 v60, v58
    s_nop 1
    v_permlane32_swap_b32 v58, v60
    v_add_f32 v58, v58, v60
    v_add_f32_dpp v59, v59, v59 quad_perm:[1,0,3,2] row_mask:0xf bank_mask:0xf
    s_nop 1
    v_add_f32_dpp v59, v59, v59 quad_perm:[2,3,0,1] row_mask:0xf bank_mask:0xf
    s_nop 1
    v_add_f32_dpp v59, v59, v59 row_half_mirror row_mask:0xf bank_mask:0xf
    s_nop 1
    v_add_f32_dpp v59, v59, v59 row_mirror row_mask:0xf bank_mask:0xf
    v_mov_b32 v60, v59
    s_nop 1
    v_permlane16_swap_b32 v59, v60
    v_add_f32 v59, v59, v60
    v_mov_b32 v60, v59
    s_nop 1
    v_permlane32_swap_b32 v59, v60
    v_add_f32 v59, v59, v60
    v_mul_f32 v58, 0xbfb8aa3b, v58
    v_exp_f32 v58, v58
    s_nop 0
    v_add_f32 v58, 1.0, v58
    v_rcp_f32 v58, v58
    v_mul_f32 v59, 0xbfb8aa3b, v59
    v_exp_f32 v59, v59
    s_nop 0
    v_add_f32 v59, 1.0, v59
    v_rcp_f32 v59, v59
    v_mov_b32 v60, 0xb040
    ds_write_b64 v60, v[58:59]
    s_waitcnt lgkmcnt(0)
L_F_nogate:
    s_cmp_lt_u32 s8, 4
    s_cbranch_scc1 nouk2_3
    v_xor_b32 v232, v1, v2
    v_lshlrev_b32 v232, 4, v232
    v_lshl_add_u32 v232, v1, 8, v232
    v_add_u32 v232, s62, v232
    s_waitcnt vmcnt(0)
    v_xor_b32 v233, 0, v232
    ds_read_b128 v[32:35], v233 offset:0
    ds_read_b128 v[48:51], v233 offset:4096
    v_xor_b32 v233, 64, v232
    ds_read_b128 v[36:39], v233 offset:0
    ds_read_b128 v[52:55], v233 offset:4096
    v_xor_b32 v233, 128, v232
    ds_read_b128 v[40:43], v233 offset:0
    ds_read_b128 v[56:59], v233 offset:4096
    v_xor_b32 v233, 192, v232
    ds_read_b128 v[44:47], v233 offset:0
    ds_read_b128 v[60:63], v233 offset:4096
nouk2_3:
    s_mov_b32 s51, 0
    s_mov_b32 s49, 300000
poll_4:
    global_load_dwordx4 v[208:211], v13, s[54:55] sc1
    s_waitcnt vmcnt(0)
    v_xor_b32 v232, s44, v208
    v_bitop3_b32 v232, v232, v209, s45 bitop3:0xf6
    v_bitop3_b32 v232, v232, v210, s46 bitop3:0xf6
    v_bitop3_b32 v232, v232, v211, s47 bitop3:0xf6
    v_and_b32 v232, s48, v232
    v_cmp_ne_u32 vcc, 0, v232
    s_cbranch_vccz pdone_5
    s_sub_u32 s49, s49, 1
    s_cbranch_scc1 pdone_5
    s_add_u32 s51, s51, 1
    s_cmp_ge_u32 s51, 40
    s_cselect_b32 s10, 0x40000, 0
    v_xor_b32 v13, s10, v13
    s_sleep 2
    s_branch poll_4
pdone_5:
    v_xor_b32 v208, s44, v208
    v_xor_b32 v209, s45, v209
    v_xor_b32 v210, s46, v210
    v_xor_b32 v211, s47, v211
    v_cvt_pk_bf16_f32 v212, v208, v209
    v_cvt_pk_bf16_f32 v213, v210, v211
    ds_write_b64 v14, v[212:213]
    s_waitcnt lgkmcnt(0)
    s_barrier
    s_cmp_lt_u32 s8, 4
    s_cbranch_scc1 L_F_nos2
    ds_read_b128 v[212:215], v15 offset:0
    ds_read_b128 v[216:219], v15 offset:64
    ds_read_b128 v[220:223], v15 offset:128
    ds_read_b128 v[224:227], v15 offset:192
    s_mov_b32 s10, 0x11111111
    s_mov_b32 s11, 0x11111111
    s_waitcnt lgkmcnt(3)
    v_mfma_f32_16x16x32_bf16 v[236:239], v[32:35], v[212:215], 0
    v_mfma_f32_16x16x32_bf16 v[240:243], v[48:51], v[212:215], 0
    s_waitcnt lgkmcnt(2)
    v_mfma_f32_16x16x32_bf16 v[236:239], v[36:39], v[216:219], v[236:239]
    v_mfma_f32_16x16x32_bf16 v[240:243], v[52:55], v[216:219], v[240:243]
    s_waitcnt lgkmcnt(1)
    v_mfma_f32_16x16x32_bf16 v[236:239], v[40:43], v[220:223], v[236:239]
    v_mfma_f32_16x16x32_bf16 v[240:243], v[56:59], v[220:223], v[240:243]
    s_waitcnt lgkmcnt(0)
    v_mfma_f32_16x16x32_bf16 v[236:239], v[44:47], v[224:227], v[236:239]
    v_mfma_f32_16x16x32_bf16 v[240:243], v[60:63], v[224:227], v[240:243]
    s_nop 6
    v_add_f32_dpp v208, v236, v236 row_half_mirror row_mask:0xf bank_mask:0x5
    v_add_f32_dpp v209, v237, v237 row_half_mirror row_mask:0xf bank_mask:0x5
    v_add_f32_dpp v210, v238, v238 row_half_mirror row_mask:0xf bank_mask:0x5
    v_add_f32_dpp v211, v239, v239 row_half_mirror row_mask:0xf bank_mask:0x5
    v_add_f32_dpp v208, v240, v240 row_half_mirror row_mask:0xf bank_mask:0xa
    v_add_f32_dpp v209, v241, v241 row_half_mirror row_mask:0xf bank_mask:0xa
    v_add_f32_dpp v210, v242, v242 row_half_mirror row_mask:0xf bank_mask:0xa
    v_add_f32_dpp v211, v243, v243 row_half_mirror row_mask:0xf bank_mask:0xa
    v_add_f32_dpp v208, v208, v208 quad_perm:[1,0,3,2] row_mask:0xf bank_mask:0xf
    v_add_f32_dpp v209, v209, v209 quad_perm:[1,0,3,2] row_mask:0xf bank_mask:0xf
    v_add_f32_dpp v210, v210, v210 quad_perm:[1,0,3,2] row_mask:0xf bank_mask:0xf
    v_add_f32_dpp v211, v211, v211 quad_perm:[1,0,3,2] row_mask:0xf bank_mask:0xf
    v_add_f32_dpp v208, v208, v208 quad_perm:[2,3,0,1] row_mask:0xf bank_mask:0xf
    v_add_f32_dpp v209, v209, v209 quad_perm:[2,3,0,1] row_mask:0xf bank_mask:0xf
    v_add_f32_dpp v210, v210, v210 quad_perm:[2,3,0,1] row_mask:0xf bank_mask:0xf
    v_add_f32_dpp v211, v211, v211 quad_perm:[2,3,0,1] row_mask:0xf bank_mask:0xf
    v_mul_f32 v208, 0x3e0293ee, v208
    v_mul_f32 v209, 0x3e0293ee, v209
    v_mul_f32 v210, 0x3e0293ee, v210
    v_mul_f32 v211, 0x3e0293ee, v211
    v_perm_b32 v236, v209, v208, v16
    v_perm_b32 v237, v211, v210, v16
    v_pk_add_u16 v236, v236, 1 op_sel_hi:[1,0]
    v_pk_add_u16 v237, v237, 1 op_sel_hi:[1,0]
    v_and_or_b32 v236, v236, v17, v18
    v_and_or_b32 v237, v237, v17, v20
    s_mov_b64 exec, s[10:11]
    global_store_dwordx2 v3, v[236:237], s[60:61] sc1
    s_mov_b64 exec, -1
L_F_nos2:
    s_lshl_b32 s15, s8, 12
    s_add_u32 s15, s15, 0x2000
    s_mov_b32 m0, s15
    s_sub_u32 s14, s8, 3
    s_max_i32 s14, s14, 0
    v_lshrrev_b32 v246, 2, v0
    v_lshlrev_b32 v246, 13, v246
    v_and_b32 v84, 3, v0
    v_lshl_add_u32 v246, v84, 4, v246
    s_lshl_b32 s10, s8, 19
    s_lshl_b32 s11, s7, 8
    s_add_u32 s10, s10, s11
    s_lshl_b32 s11, s5, 6
    s_add_u32 s10, s10, s11
    s_add_u32 s56, s24, s10
    s_addc_u32 s57, s25, 0
    v_mov_b32 v86, 0xb040
    ds_read_b64 v[86:87], v86
    s_barrier
    s_cmp_lg_u32 s8, 3
    s_cbranch_scc1 nohint_6
    s_lshr_b32 s51, s2, 3
    s_lshl_b32 s10, s4, 8
    s_lshl_b32 s11, s51, 4
    s_add_u32 s10, s10, s11
    s_add_u32 s10, s10, 0x2000
    s_add_u32 s12, s42, s10
    s_addc_u32 s13, s43, 0
    v_mov_b32 v232, s44
    v_mov_b32 v233, s45
    v_mov_b32 v234, s46
    v_mov_b32 v235, s47
    v_mov_b32 v236, 0
    s_mov_b64 exec, 1
    global_store_dwordx4 v236, v[232:235], s[12:13]
    s_mov_b64 exec, -1
    s_nop 0
nohint_6:
    s_waitcnt lgkmcnt(0)
    v_readfirstlane_b32 s54, v86
    v_readfirstlane_b32 s55, v87
    s_bfe_u32 s51, s2, 0x30003
    s_bfe_u32 s58, s2, 0x10006
    s_lshl_b32 s10, s4, 18
    s_lshl_b32 s11, s58, 17
    s_add_u32 s10, s10, s11
    s_lshl_b32 s11, s51, 14
    s_add_u32 s10, s10, s11
    s_lshl_b32 s11, s8, 11
    s_add_u32 s10, s10, s11
    s_add_u32 s10, s10, 0x400000
    s_add_u32 s12, s42, s10
    s_addc_u32 s13, s43, 0
    v_lshlrev_b32 v3, 4, v0
    global_load_dwordx4 v[248:251], v3, s[12:13] sc1
    global_load_dwordx4 v[252:255], v3, s[12:13] offset:1024 sc1
    s_cmp_lg_u32 s8, 0
    s_cbranch_scc1 nomlpre_7
    s_lshl_b32 s10, s4, 12
    s_lshl_b32 s11, s58, 11
    s_add_u32 s10, s10, s11
    s_lshl_b32 s11, s51, 8
    s_add_u32 s10, s10, s11
    s_add_u32 s10, s10, 0x8000
    s_add_u32 s12, s42, s10
    s_addc_u32 s13, s43, 0
    v_lshlrev_b32 v3, 2, v0
    global_load_dword v247, v3, s[12:13] sc1
    s_nop 0
nomlpre_7:
    global_load_lds_dwordx4 v246, s[56:57] offset:0
    v_add_u32 v246, 0x1fc00, v246
    global_load_lds_dwordx4 v246, s[56:57] offset:1024
    v_add_u32 v246, 0x1fc00, v246
    global_load_lds_dwordx4 v246, s[56:57] offset:2048
    v_add_u32 v246, 0x1fc00, v246
    global_load_lds_dwordx4 v246, s[56:57] offset:3072
    s_cmp_lt_u32 s8, 3
    s_cbranch_scc1 L_F_nowo
    v_mul_u32_u24 v3, 10240, v2
    v_lshl_add_u32 v3, v1, 4, v3
    s_mul_i32 s10, s7, 163840
    s_mul_i32 s11, s5, 40960
    s_add_u32 s10, s10, s11
    s_lshl_b32 s11, s14, 8
    s_add_u32 s10, s10, s11
    s_add_u32 s12, s26, s10
    s_addc_u32 s13, s27, 0
    global_load_dwordx4 v[16:19], v3, s[12:13] offset:0 nt
    global_load_dwordx4 v[20:23], v3, s[12:13] offset:1280 nt
    global_load_dwordx4 v[24:27], v3, s[12:13] offset:2560 nt
    global_load_dwordx4 v[28:31], v3, s[12:13] offset:3840 nt
    v_add_u32 v3, 5120, v3
    global_load_dwordx4 v[32:35], v3, s[12:13] offset:0 nt
    global_load_dwordx4 v[36:39], v3, s[12:13] offset:1280 nt
    global_load_dwordx4 v[40:43], v3, s[12:13] offset:2560 nt
    global_load_dwordx4 v[44:47], v3, s[12:13] offset:3840 nt
L_F_nowo:
    v_lshrrev_b32 v244, 2, v1
    v_lshl_add_u32 v244, v2, 3, v244
    v_lshlrev_b32 v244, 6, v244
    v_and_b32 v84, 3, v0
    v_lshl_add_u32 v244, v84, 3, v244
    v_add_u32 v244, s15, v244
    s_nop 1
L_F_s4:
    s_waitcnt vmcnt(0)
    ds_read_b64_tr_b16 v[64:65], v244 offset:0
    ds_read_b64_tr_b16 v[66:67], v244 offset:256
    ds_read_b64_tr_b16 v[68:69], v244 offset:2048
    ds_read_b64_tr_b16 v[70:71], v244 offset:2304
    ds_read_b64_tr_b16 v[72:73], v244 offset:32
    ds_read_b64_tr_b16 v[74:75], v244 offset:288
    ds_read_b64_tr_b16 v[76:77], v244 offset:2080
    ds_read_b64_tr_b16 v[78:79], v244 offset:2336
    v_and_b32 v85, 7, v0
    v_lshlrev_b32 v3, 6, v85
    v_lshl_add_u32 v3, v2, 4, v3
    v_lshlrev_b32 v85, 4, v85
    s_lshl_b32 s10, s7, 13
    s_lshl_b32 s11, s8, 10
    s_add_u32 s10, s10, s11
    s_add_u32 s10, s10, 0x140000
    s_add_u32 s56, s42, s10
    s_addc_u32 s57, s43, 0
    s_lshl_b32 s10, s7, 7
    s_add_u32 s10, s10, 0x10000
    s_add_u32 s52, s42, s10
    s_addc_u32 s53, s43, 0
    v_mov_b32 v84, s54
    v_mov_b32 v87, s55
    v_bfe_u32 v86, v0, 2, 1
    v_cmp_eq_u32 vcc, 1, v86
    s_nop 1
    v_cndmask_b32 v84, v84, v87, vcc
    v_mul_u32_u24 v13, 144, v86
    v_lshl_add_u32 v13, v2, 4, v13
    s_mul_i32 s10, s8, 288
    s_add_u32 s10, s10, 0xa000
    v_add_u32 v13, s10, v13
    v_and_b32 v14, 7, v0
    v_lshlrev_b32 v14, 1, v14
    v_bfe_u32 v86, v0, 3, 1
    v_add_u32 v14, v14, v86
    v_mul_u32_u24 v14, 144, v14
    v_lshl_add_u32 v14, v2, 5, v14
    v_add_u32 v14, 0xa000, v14
    v_lshrrev_b32 v15, 5, v0
    v_mul_u32_u24 v15, 40, v15
    v_lshrrev_b32 v86, 1, v1
    v_add_u32 v15, v15, v86
    v_lshlrev_b32 v15, 14, v15
    v_and_b32 v86, 1, v0
    v_lshl_add_u32 v15, v86, 5, v15
    v_and_b32 v86, 1, v2
    v_lshl_add_u32 v15, v86, 4, v15
    s_max_i32 s14, s14, 0
    s_lshl_b32 s10, s14, 17
    s_lshl_b32 s11, s2, 6
    s_add_u32 s10, s10, s11
    s_add_u32 s10, s10, 0x200000
    s_add_u32 s60, s42, s10
    s_addc_u32 s61, s43, 0
    s_mov_b32 s58, 0x00110011
    s_mov_b32 s59, 0x00110011
    s_cmp_lg_u32 s8, 2
    s_cbranch_scc1 hwd_9
    v_lshlrev_b32 v92, 4, v1
    s_lshl_b32 s10, s4, 8
    s_add_u32 s10, s10, 0x3000
    s_add_u32 s12, s42, s10
    s_addc_u32 s13, s43, 0
    s_movk_i32 s49, 100
    s_mov_b64 exec, 0xffff
hw_8:
    global_load_dwordx4 v[88:91], v92, s[12:13] sc1
    s_waitcnt vmcnt(0)
    v_xor_b32 v93, s44, v88
    v_bitop3_b32 v93, v93, v89, s45 bitop3:0xf6
    v_bitop3_b32 v93, v93, v90, s46 bitop3:0xf6
    v_bitop3_b32 v93, v93, v91, s47 bitop3:0xf6
    v_and_b32 v93, s48, v93
    v_cmp_ne_u32 vcc, 0, v93
    s_cbranch_vccz hwd_9
    s_sleep 1
    s_sub_u32 s49, s49, 1
    s_cbranch_scc0 hw_8
    s_nop 0
hwd_9:
    s_mov_b64 exec, -1
    s_barrier
    s_mov_b32 s49, 300000
    global_load_dwordx4 v[128:131], v3, s[56:57] offset:0 sc1
    global_load_dwordx4 v[132:135], v3, s[56:57] offset:512 sc1
    global_load_dwordx4 v[104:107], v85, s[52:53] sc1
poll_10:
    s_waitcnt vmcnt(0)
    v_xor_b32 v128, s28, v128
    v_xor_b32 v129, s29, v129
    v_xor_b32 v130, s40, v130
    v_xor_b32 v131, s41, v131
    v_xor_b32 v132, s28, v132
    v_xor_b32 v133, s29, v133
    v_xor_b32 v134, s40, v134
    v_xor_b32 v135, s41, v135
    v_or_b32 v86, v128, v129
    v_or3_b32 v86, v86, v130, v131
    v_or3_b32 v86, v86, v132, v133
    v_or3_b32 v86, v86, v134, v135
    v_and_b32 v86, 0x10001, v86
    v_xor_b32 v87, s44, v104
    v_bitop3_b32 v87, v87, v105, s45 bitop3:0xf6
    v_bitop3_b32 v87, v87, v106, s46 bitop3:0xf6
    v_bitop3_b32 v87, v87, v107, s47 bitop3:0xf6
    v_and_or_b32 v86, v87, s48, v86
    v_cmp_ne_u32 vcc, 0, v86
    s_cbranch_vccz pdone_11
    s_sub_u32 s49, s49, 1
    s_cbranch_scc1 pdone_11
    s_or_b32 s10, vcc_lo, vcc_hi
    s_lshr_b32 s11, s10, 16
    s_or_b32 s10, s10, s11
    s_and_b32 s10, s10, 0xffff
    s_mul_i32 s10, s10, 0x10001
    s_mov_b32 exec_lo, s10
    s_mov_b32 exec_hi, s10
    s_sleep 1
    global_load_dwordx4 v[128:131], v3, s[56:57] offset:0 sc1
    global_load_dwordx4 v[132:135], v3, s[56:57] offset:512 sc1
    global_load_dwordx4 v[104:107], v85, s[52:53] sc1
    s_branch poll_10
pdone_11:
    s_mov_b64 exec, -1
    s_waitcnt lgkmcnt(0)
    v_mfma_f32_16x16x32_bf16 v[112:115], v[64:67], v[128:131], 0
    v_mfma_f32_16x16x32_bf16 v[112:115], v[68:71], v[132:135], v[112:115]
    v_mfma_f32_16x16x32_bf16 v[116:119], v[72:75], v[128:131], 0
    v_mfma_f32_16x16x32_bf16 v[116:119], v[76:79], v[132:135], v[116:119]
    v_lshrrev_b32 v105, 12, v105
    v_bfi_b32 v104, s48, v105, v104
    s_nop 1
    v_max_f32_dpp v86, v104, v104 quad_perm:[1,0,3,2] row_mask:0xf bank_mask:0xf
    v_xor_b32 v106, s46, v106
    s_nop 0
    v_max_f32_dpp v86, v86, v86 quad_perm:[2,3,0,1] row_mask:0xf bank_mask:0xf
    v_sub_f32 v86, v104, v86
    v_exp_f32 v86, v86
    s_nop 0
    v_mul_f32 v87, v86, v106
    v_mul_f32 v86, v86, v84
    s_nop 0
    v_add_f32_dpp v87, v87, v87 quad_perm:[1,0,3,2] row_mask:0xf bank_mask:0xf
    s_nop 1
    v_add_f32_dpp v87, v87, v87 quad_perm:[2,3,0,1] row_mask:0xf bank_mask:0xf
    v_rcp_f32 v87, v87
    s_nop 0
    v_mul_f32 v86, v86, v87
    v_mul_f32 v112, v112, v86
    v_mul_f32 v113, v113, v86
    v_mul_f32 v114, v114, v86
    v_mul_f32 v115, v115, v86
    v_mul_f32 v116, v116, v86
    v_mul_f32 v117, v117, v86
    v_mul_f32 v118, v118, v86
    v_mul_f32 v119, v119, v86
    v_add_f32_dpp v112, v112, v112 quad_perm:[1,0,3,2] row_mask:0xf bank_mask:0xf
    v_add_f32_dpp v113, v113, v113 quad_perm:[1,0,3,2] row_mask:0xf bank_mask:0xf
    v_add_f32_dpp v114, v114, v114 quad_perm:[1,0,3,2] row_mask:0xf bank_mask:0xf
    v_add_f32_dpp v115, v115, v115 quad_perm:[1,0,3,2] row_mask:0xf bank_mask:0xf
    v_add_f32_dpp v116, v116, v116 quad_perm:[1,0,3,2] row_mask:0xf bank_mask:0xf
    v_add_f32_dpp v117, v117, v117 quad_perm:[1,0,3,2] row_mask:0xf bank_mask:0xf
    v_add_f32_dpp v118, v118, v118 quad_perm:[1,0,3,2] row_mask:0xf bank_mask:0xf
    v_add_f32_dpp v119, v119, v119 quad_perm:[1,0,3,2] row_mask:0xf bank_mask:0xf
    v_add_f32_dpp v112, v112, v112 quad_perm:[2,3,0,1] row_mask:0xf bank_mask:0xf
    v_add_f32_dpp v113, v113, v113 quad_perm:[2,3,0,1] row_mask:0xf bank_mask:0xf
    v_add_f32_dpp v114, v114, v114 quad_perm:[2,3,0,1] row_mask:0xf bank_mask:0xf
    v_add_f32_dpp v115, v115, v115 quad_perm:[2,3,0,1] row_mask:0xf bank_mask:0xf
    v_add_f32_dpp v116, v116, v116 quad_perm:[2,3,0,1] row_mask:0xf bank_mask:0xf
    v_add_f32_dpp v117, v117, v117 quad_perm:[2,3,0,1] row_mask:0xf bank_mask:0xf
    v_add_f32_dpp v118, v118, v118 quad_perm:[2,3,0,1] row_mask:0xf bank_mask:0xf
    v_add_f32_dpp v119, v119, v119 quad_perm:[2,3,0,1] row_mask:0xf bank_mask:0xf
    s_mov_b64 exec, s[58:59]
    ds_write_b128 v13, v[112:115]
    ds_write_b128 v13, v[116:119] offset:64
    s_mov_b64 exec, -1
    s_waitcnt lgkmcnt(0)
    s_barrier
    s_cmp_lt_u32 s8, 3
    s_cbranch_scc1 L_F_fin
    ds_read_b128 v[88:91], v14
    ds_read_b128 v[92:95], v14 offset:16
    s_waitcnt lgkmcnt(0)
    v_add_f32_dpp v88, v88, v88 quad_perm:[1,0,3,2] row_mask:0xf bank_mask:0xf
    v_add_f32_dpp v89, v89, v89 quad_perm:[1,0,3,2] row_mask:0xf bank_mask:0xf
    v_add_f32_dpp v90, v90, v90 quad_perm:[1,0,3,2] row_mask:0xf bank_mask:0xf
    v_add_f32_dpp v91, v91, v91 quad_perm:[1,0,3,2] row_mask:0xf bank_mask:0xf
    v_add_f32_dpp v92, v92, v92 quad_perm:[1,0,3,2] row_mask:0xf bank_mask:0xf
    v_add_f32_dpp v93, v93, v93 quad_perm:[1,0,3,2] row_mask:0xf bank_mask:0xf
    v_add_f32_dpp v94, v94, v94 quad_perm:[1,0,3,2] row_mask:0xf bank_mask:0xf
    v_add_f32_dpp v95, v95, v95 quad_perm:[1,0,3,2] row_mask:0xf bank_mask:0xf
    v_add_f32_dpp v88, v88, v88 quad_perm:[2,3,0,1] row_mask:0xf bank_mask:0xf
    v_add_f32_dpp v89, v89, v89 quad_perm:[2,3,0,1] row_mask:0xf bank_mask:0xf
    v_add_f32_dpp v90, v90, v90 quad_perm:[2,3,0,1] row_mask:0xf bank_mask:0xf
    v_add_f32_dpp v91, v91, v91 quad_perm:[2,3,0,1] row_mask:0xf bank_mask:0xf
    v_add_f32_dpp v92, v92, v92 quad_perm:[2,3,0,1] row_mask:0xf bank_mask:0xf
    v_add_f32_dpp v93, v93, v93 quad_perm:[2,3,0,1] row_mask:0xf bank_mask:0xf
    v_add_f32_dpp v94, v94, v94 quad_perm:[2,3,0,1] row_mask:0xf bank_mask:0xf
    v_add_f32_dpp v95, v95, v95 quad_perm:[2,3,0,1] row_mask:0xf bank_mask:0xf
    v_add_f32_dpp v88, v88, v88 row_half_mirror row_mask:0xf bank_mask:0xf
    v_add_f32_dpp v89, v89, v89 row_half_mirror row_mask:0xf bank_mask:0xf
    v_add_f32_dpp v90, v90, v90 row_half_mirror row_mask:0xf bank_mask:0xf
    v_add_f32_dpp v91, v91, v91 row_half_mirror row_mask:0xf bank_mask:0xf
    v_add_f32_dpp v92, v92, v92 row_half_mirror row_mask:0xf bank_mask:0xf
    v_add_f32_dpp v93, v93, v93 row_half_mirror row_mask:0xf bank_mask:0xf
    v_add_f32_dpp v94, v94, v94 row_half_mirror row_mask:0xf bank_mask:0xf
    v_add_f32_dpp v95, v95, v95 row_half_mirror row_mask:0xf bank_mask:0xf
    v_cvt_pk_bf16_f32 v88, v88, v89
    v_cvt_pk_bf16_f32 v89, v90, v91
    v_cvt_pk_bf16_f32 v90, v92, v93
    v_cvt_pk_bf16_f32 v91, v94, v95
    v_perm_b32 v128, v88, v88, v4
    v_perm_b32 v129, v88, v88, v5
    v_perm_b32 v130, v88, v88, v6
    v_perm_b32 v131, v88, v88, v7
    v_perm_b32 v132, v88, v88, v8
    v_perm_b32 v133, v88, v88, v9
    v_perm_b32 v134, v88, v88, v10
    v_perm_b32 v135, v88, v88, v11
    v_mfma_f32_16x16x32_bf16 v[80:83], v[128:131], v[16:19], 0
    v_perm_b32 v136, v89, v89, v4
    v_perm_b32 v137, v89, v89, v5
    v_perm_b32 v138, v89, v89, v6
    v_perm_b32 v139, v89, v89, v7
    v_mfma_f32_16x16x32_bf16 v[80:83], v[132:135], v[20:23], v[80:83]
    v_perm_b32 v140, v89, v89, v8
    v_perm_b32 v141, v89, v89, v9
    v_perm_b32 v142, v89, v89, v10
    v_perm_b32 v143, v89, v89, v11
    v_mfma_f32_16x16x32_bf16 v[80:83], v[136:139], v[24:27], v[80:83]
    v_perm_b32 v144, v90, v90, v4
    v_perm_b32 v145, v90, v90, v5
    v_perm_b32 v146, v90, v90, v6
    v_perm_b32 v147, v90, v90, v7
    v_mfma_f32_16x16x32_bf16 v[80:83], v[140:143], v[28:31], v[80:83]
    v_perm_b32 v148, v90, v90, v8
    v_perm_b32 v149, v90, v90, v9
    v_perm_b32 v150, v90, v90, v10
    v_perm_b32 v151, v90, v90, v11
    v_mfma_f32_16x16x32_bf16 v[80:83], v[144:147], v[32:35], v[80:83]
    v_perm_b32 v152, v91, v91, v4
    v_perm_b32 v153, v91, v91, v5
    v_perm_b32 v154, v91, v91, v6
    v_perm_b32 v155, v91, v91, v7
    v_mfma_f32_16x16x32_bf16 v[80:83], v[148:151], v[36:39], v[80:83]
    v_perm_b32 v156, v91, v91, v8
    v_perm_b32 v157, v91, v91, v9
    v_perm_b32 v158, v91, v91, v10
    v_perm_b32 v159, v91, v91, v11
    v_mfma_f32_16x16x32_bf16 v[80:83], v[152:155], v[40:43], v[80:83]
    s_nop 0
    v_mfma_f32_16x16x32_bf16 v[80:83], v[156:159], v[44:47], v[80:83]
    s_nop 7
    v_add_u32 v80, 0x800, v80
    v_add_u32 v81, 0x800, v81
    v_add_u32 v82, 0x800, v82
    v_add_u32 v83, 0x800, v83
    v_and_or_b32 v80, v80, v12, s44
    v_and_or_b32 v81, v81, v12, s45
    v_and_or_b32 v82, v82, v12, s46
    v_and_or_b32 v83, v83, v12, s47
    global_store_dwordx4 v15, v[80:83], s[60:61] sc1
    s_nop 1
L_F_fin:
    s_cmp_ge_u32 s2, 80
    s_cbranch_scc1 L_bend
    v_lshlrev_b32 v3, 4, v0
    s_lshl_b32 s10, s2, 14
    s_lshl_b32 s11, s8, 10
    s_add_u32 s10, s10, s11
    s_add_u32 s10, s10, 0x200000
    s_add_u32 s12, s42, s10
    s_addc_u32 s13, s43, 0
    v_add_u32 v246, 0x2000, v3
    s_lshl_b32 s10, s2, 5
    s_add_u32 s52, s38, s10
    s_addc_u32 s53, s39, 0
    v_and_b32 v13, 3, v0
    v_lshlrev_b32 v13, 2, v13
    v_add_u32 v13, v13, v2
    v_lshlrev_b32 v13, 5, v13
    s_lshl_b32 s10, s8, 2
    s_add_u32 s10, s10, 0xb100
    v_add_u32 v13, s10, v13
    v_lshlrev_b32 v14, 5, v1
    v_add_u32 v14, 0xb100, v14
    v_lshlrev_b32 v15, 1, v1
    s_mov_b32 s58, 0x000f000f
    s_mov_b32 s59, 0x000f000f
    s_barrier
    s_sleep 12
    s_mov_b32 s49, 300000
    global_load_dwordx4 v[88:91], v3, s[12:13] sc1
    global_load_dwordx4 v[92:95], v246, s[12:13] sc1
poll_13:
    s_waitcnt vmcnt(0)
    v_xor_b32 v86, s44, v88
    v_bitop3_b32 v86, v86, v89, s45 bitop3:0xf6
    v_bitop3_b32 v86, v86, v90, s46 bitop3:0xf6
    v_bitop3_b32 v86, v86, v91, s47 bitop3:0xf6
    v_bitop3_b32 v86, v86, v92, s44 bitop3:0xf6
    v_bitop3_b32 v86, v86, v93, s45 bitop3:0xf6
    v_bitop3_b32 v86, v86, v94, s46 bitop3:0xf6
    v_bitop3_b32 v86, v86, v95, s47 bitop3:0xf6
    v_and_b32 v86, s48, v86
    v_cmp_ne_u32 vcc, 0, v86
    s_cbranch_vccz pdone_14
    s_sub_u32 s49, s49, 1
    s_cbranch_scc1 pdone_14
    s_or_b32 s10, vcc_lo, vcc_hi
    s_lshr_b32 s11, s10, 16
    s_or_b32 s10, s10, s11
    s_and_b32 s10, s10, 0xffff
    s_mul_i32 s10, s10, 0x10001
    s_mov_b32 exec_lo, s10
    s_mov_b32 exec_hi, s10
    s_sleep 1
    global_load_dwordx4 v[88:91], v3, s[12:13] sc1
    global_load_dwordx4 v[92:95], v246, s[12:13] sc1
    s_branch poll_13
pdone_14:
    s_mov_b64 exec, -1
    v_xor_b32 v88, s44, v88
    v_xor_b32 v89, s45, v89
    v_xor_b32 v90, s46, v90
    v_xor_b32 v91, s47, v91
    v_xor_b32 v92, s44, v92
    v_xor_b32 v93, s45, v93
    v_xor_b32 v94, s46, v94
    v_xor_b32 v95, s47, v95
    v_pk_add_f32 v[88:89], v[88:89], v[92:93]
    v_pk_add_f32 v[90:91], v[90:91], v[94:95]
    s_nop 1
    v_permlane32_swap_b32 v88, v90
    v_permlane32_swap_b32 v89, v91
    v_pk_add_f32 v[88:89], v[88:89], v[90:91]
    s_nop 1
    v_permlane16_swap_b32 v88, v89
    v_add_f32 v88, v88, v89
    s_nop 1
    v_add_f32_dpp v88, v88, v88 row_ror:4 row_mask:0xf bank_mask:0xf
    s_nop 1
    v_add_f32_dpp v88, v88, v88 row_ror:8 row_mask:0xf bank_mask:0xf
    s_mov_b64 exec, s[58:59]
    ds_write_b32 v13, v88
    s_mov_b64 exec, -1
    s_waitcnt lgkmcnt(0)
    s_barrier
    s_cmp_lg_u32 s8, 0
    s_cbranch_scc1 L_bend
    ds_read_b128 v[88:91], v14
    ds_read_b128 v[92:95], v14 offset:16
    s_waitcnt lgkmcnt(0)
    v_pk_add_f32 v[88:89], v[88:89], v[92:93]
    v_pk_add_f32 v[90:91], v[90:91], v[94:95]
    v_pk_add_f32 v[88:89], v[88:89], v[90:91]
    v_add_f32 v88, v88, v89
    v_cvt_pk_bf16_f32 v88, v88, v88
    s_mov_b64 exec, 0xffff
    global_store_short v15, v88, s[52:53]
    s_cmp_lg_u32 s2, 0
    s_cbranch_scc1 L_bend2
    s_mov_b64 exec, 1
    v_mov_b32 v90, s9
    global_store_dword v15, v90, s[42:43]
    s_nop 0
L_bend2:
    s_mov_b64 exec, -1
L_bend:
    s_endpgm
L_A:
    s_bfe_u32 s5, s2, 0x30003
    s_bfe_u32 s6, s2, 0x10006
    s_and_b32 s51, s4, 1
    s_lshr_b32 s52, s4, 1
    s_lshl_b32 s14, s8, 14
    s_mov_b32 m0, s14
    s_lshl_b32 s15, s4, 1
    s_add_u32 s15, s15, s6
    s_cmp_ge_u32 s8, 2
    s_cbranch_scc1 L_A_nos1
    s_setprio 3
    s_bfe_u32 s62, s2, 0x20005
    s_lshl_b32 s62, s62, 3
    s_add_u32 s62, s62, s4
    s_bfe_u32 s63, s2, 0x20003
    s_lshl_b32 s63, s63, 1
    s_add_u32 s63, s63, s8
    s_mov_b32 s11, 163840
    v_mul_lo_u32 v3, v2, s11
    v_lshl_add_u32 v3, v1, 4, v3
    s_mov_b32 s60, s14
    s_mov_b32 s14, s63
    s_waitcnt lgkmcnt(0)
    s_load_dword s9, s[42:43], 0
    v_bfe_u32 v126, v0, 3, 1
    v_mul_u32_u24 v126, 1280, v126
    v_mul_u32_u24 v127, 40, v2
    v_add_u32 v126, v126, v127
    s_mul_i32 s10, s14, 160
    s_add_u32 s12, s16, s10
    s_addc_u32 s13, s17, 0
    global_load_dwordx4 v[112:115], v126, s[12:13]
    global_load_dwordx4 v[116:119], v126, s[12:13] offset:16
    global_load_dwordx2 v[120:121], v126, s[12:13] offset:32
    s_mov_b32 s14, s60
    s_mul_i32 s10, s63, 655360
    s_lshl_b32 s11, s62, 8
    s_add_u32 s10, s10, s11
    s_add_u32 s12, s20, s10
    s_addc_u32 s13, s21, 0
    global_load_dwordx4 v[32:35], v3, s[12:13] nt
    v_add_u32 v3, 0x2000, v3
    global_load_dwordx4 v[36:39], v3, s[12:13] nt
    v_add_u32 v3, 0x2000, v3
    global_load_dwordx4 v[40:43], v3, s[12:13] nt
    v_add_u32 v3, 0x2000, v3
    global_load_dwordx4 v[44:47], v3, s[12:13] nt
    v_add_u32 v3, 0x2000, v3
    global_load_dwordx4 v[48:51], v3, s[12:13] nt
    v_add_u32 v3, 0x2000, v3
    global_load_dwordx4 v[52:55], v3, s[12:13] nt
    v_add_u32 v3, 0x2000, v3
    global_load_dwordx4 v[56:59], v3, s[12:13] nt
    v_add_u32 v3, 0x2000, v3
    global_load_dwordx4 v[60:63], v3, s[12:13] nt
    v_add_u32 v3, 0x2000, v3
    global_load_dwordx4 v[64:67], v3, s[12:13] nt
    v_add_u32 v3, 0x2000, v3
    global_load_dwordx4 v[68:71], v3, s[12:13] nt
    v_add_u32 v3, 0x2000, v3
    global_load_dwordx4 v[72:75], v3, s[12:13] nt
    v_add_u32 v3, 0x2000, v3
    global_load_dwordx4 v[76:79], v3, s[12:13] nt
    v_add_u32 v3, 0x2000, v3
    global_load_dwordx4 v[80:83], v3, s[12:13] nt
    v_add_u32 v3, 0x2000, v3
    global_load_dwordx4 v[84:87], v3, s[12:13] nt
    v_add_u32 v3, 0x2000, v3
    global_load_dwordx4 v[88:91], v3, s[12:13] nt
    v_add_u32 v3, 0x2000, v3
    global_load_dwordx4 v[92:95], v3, s[12:13] nt
    v_add_u32 v3, 0x2000, v3
    global_load_dwordx4 v[96:99], v3, s[12:13] nt
    v_add_u32 v3, 0x2000, v3
    global_load_dwordx4 v[100:103], v3, s[12:13] nt
    v_add_u32 v3, 0x2000, v3
    global_load_dwordx4 v[104:107], v3, s[12:13] nt
    v_add_u32 v3, 0x2000, v3
    global_load_dwordx4 v[108:111], v3, s[12:13] nt
    v_and_b32 v211, 1, v0
    v_cmp_eq_u32 vcc, 1, v211
    v_mov_b32 v208, 0x0c0c0100
    v_mov_b32 v209, 0x01000c0c
    v_cndmask_b32 v208, v208, v209, vcc
    v_mov_b32 v209, 0x0c0c0302
    v_mov_b32 v210, 0x03020c0c
    v_cndmask_b32 v209, v209, v210, vcc
    v_bfe_u32 v211, v0, 1, 2
    v_mov_b32 v210, 0x0c0c0c0c
    v_cmp_eq_u32 vcc, 0, v211
    s_nop 1
    v_cndmask_b32 v4, v210, v208, vcc
    v_cndmask_b32 v8, v210, v209, vcc
    v_cmp_eq_u32 vcc, 1, v211
    s_nop 1
    v_cndmask_b32 v5, v210, v208, vcc
    v_cndmask_b32 v9, v210, v209, vcc
    v_cmp_eq_u32 vcc, 2, v211
    s_nop 1
    v_cndmask_b32 v6, v210, v208, vcc
    v_cndmask_b32 v10, v210, v209, vcc
    v_cmp_eq_u32 vcc, 3, v211
    s_nop 1
    v_cndmask_b32 v7, v210, v208, vcc
    v_cndmask_b32 v11, v210, v209, vcc
    s_waitcnt lgkmcnt(0)
    s_add_u32 s9, s9, 0x9e5
    s_and_b32 s44, s9, 0xfff
    s_add_u32 s45, s44, 0x155
    s_and_b32 s45, s45, 0xfff
    s_add_u32 s46, s44, 0x2aa
    s_and_b32 s46, s46, 0xfff
    s_add_u32 s47, s44, 0x3ff
    s_and_b32 s47, s47, 0xfff
    v_mov_b32 v12, 0xfffff000
    s_and_b32 s28, s9, 1
    s_mul_i32 s28, s28, 0x10001
    s_xor_b32 s29, s28, 1
    s_xor_b32 s40, s28, 0x10000
    s_xor_b32 s41, s28, 0x10001
    s_sub_u32 s9, s9, 0x9e5
    s_lshl_b32 s10, s62, 13
    s_lshl_b32 s11, s63, 10
    s_add_u32 s10, s10, s11
    s_add_u32 s10, s10, 0x40000
    s_add_u32 s60, s42, s10
    s_addc_u32 s61, s43, 0
    v_lshrrev_b32 v126, 5, v0
    v_lshlrev_b32 v126, 9, v126
    v_lshl_add_u32 v126, v1, 5, v126
    v_and_b32 v127, 1, v2
    v_lshl_add_u32 v126, v127, 4, v126
    s_waitcnt vmcnt(20)
    v_perm_b32 v128, v112, v112, v4
    v_perm_b32 v129, v112, v112, v5
    v_perm_b32 v130, v112, v112, v6
    v_perm_b32 v131, v112, v112, v7
    v_perm_b32 v132, v112, v112, v8
    v_perm_b32 v133, v112, v112, v9
    v_perm_b32 v134, v112, v112, v10
    v_perm_b32 v135, v112, v112, v11
    v_perm_b32 v136, v113, v113, v4
    v_perm_b32 v137, v113, v113, v5
    v_perm_b32 v138, v113, v113, v6
    v_perm_b32 v139, v113, v113, v7
    v_perm_b32 v140, v113, v113, v8
    v_perm_b32 v141, v113, v113, v9
    v_perm_b32 v142, v113, v113, v10
    v_perm_b32 v143, v113, v113, v11
    v_perm_b32 v144, v114, v114, v4
    v_perm_b32 v145, v114, v114, v5
    v_perm_b32 v146, v114, v114, v6
    v_perm_b32 v147, v114, v114, v7
    v_perm_b32 v148, v114, v114, v8
    v_perm_b32 v149, v114, v114, v9
    v_perm_b32 v150, v114, v114, v10
    v_perm_b32 v151, v114, v114, v11
    v_perm_b32 v152, v115, v115, v4
    v_perm_b32 v153, v115, v115, v5
    v_perm_b32 v154, v115, v115, v6
    v_perm_b32 v155, v115, v115, v7
    v_perm_b32 v156, v115, v115, v8
    v_perm_b32 v157, v115, v115, v9
    v_perm_b32 v158, v115, v115, v10
    v_perm_b32 v159, v115, v115, v11
    v_perm_b32 v160, v116, v116, v4
    v_perm_b32 v161, v116, v116, v5
    v_perm_b32 v162, v116, v116, v6
    v_perm_b32 v163, v116, v116, v7
    v_perm_b32 v164, v116, v116, v8
    v_perm_b32 v165, v116, v116, v9
    v_perm_b32 v166, v116, v116, v10
    v_perm_b32 v167, v116, v116, v11
    v_perm_b32 v168, v117, v117, v4
    v_perm_b32 v169, v117, v117, v5
    v_perm_b32 v170, v117, v117, v6
    v_perm_b32 v171, v117, v117, v7
    v_perm_b32 v172, v117, v117, v8
    v_perm_b32 v173, v117, v117, v9
    v_perm_b32 v174, v117, v117, v10
    v_perm_b32 v175, v117, v117, v11
    v_perm_b32 v176, v118, v118, v4
    v_perm_b32 v177, v118, v118, v5
    v_perm_b32 v178, v118, v118, v6
    v_perm_b32 v179, v118, v118, v7
    v_perm_b32 v180, v118, v118, v8
    v_perm_b32 v181, v118, v118, v9
    v_perm_b32 v182, v118, v118, v10
    v_perm_b32 v183, v118, v118, v11
    v_perm_b32 v184, v119, v119, v4
    v_perm_b32 v185, v119, v119, v5
    v_perm_b32 v186, v119, v119, v6
    v_perm_b32 v187, v119, v119, v7
    v_perm_b32 v188, v119, v119, v8
    v_perm_b32 v189, v119, v119, v9
    v_perm_b32 v190, v119, v119, v10
    v_perm_b32 v191, v119, v119, v11
    v_perm_b32 v192, v120, v120, v4
    v_perm_b32 v193, v120, v120, v5
    v_perm_b32 v194, v120, v120, v6
    v_perm_b32 v195, v120, v120, v7
    v_perm_b32 v196, v120, v120, v8
    v_perm_b32 v197, v120, v120, v9
    v_perm_b32 v198, v120, v120, v10
    v_perm_b32 v199, v120, v120, v11
    v_perm_b32 v200, v121, v121, v4
    v_perm_b32 v201, v121, v121, v5
    v_perm_b32 v202, v121, v121, v6
    v_perm_b32 v203, v121, v121, v7
    v_perm_b32 v204, v121, v121, v8
    v_perm_b32 v205, v121, v121, v9
    v_perm_b32 v206, v121, v121, v10
    v_perm_b32 v207, v121, v121, v11
    s_waitcnt vmcnt(19)
    v_mfma_f32_16x16x32_bf16 v[122:125], v[128:131], v[32:35], 0
    s_waitcnt vmcnt(18)
    v_mfma_f32_16x16x32_bf16 v[122:125], v[132:135], v[36:39], v[122:125]
    s_waitcnt vmcnt(17)
    v_mfma_f32_16x16x32_bf16 v[122:125], v[136:139], v[40:43], v[122:125]
    s_waitcnt vmcnt(16)
    v_mfma_f32_16x16x32_bf16 v[122:125], v[140:143], v[44:47], v[122:125]
    s_waitcnt vmcnt(15)
    v_mfma_f32_16x16x32_bf16 v[122:125], v[144:147], v[48:51], v[122:125]
    s_waitcnt vmcnt(14)
    v_mfma_f32_16x16x32_bf16 v[122:125], v[148:151], v[52:55], v[122:125]
    s_waitcnt vmcnt(13)
    v_mfma_f32_16x16x32_bf16 v[122:125], v[152:155], v[56:59], v[122:125]
    s_waitcnt vmcnt(12)
    v_mfma_f32_16x16x32_bf16 v[122:125], v[156:159], v[60:63], v[122:125]
    s_waitcnt vmcnt(11)
    v_mfma_f32_16x16x32_bf16 v[122:125], v[160:163], v[64:67], v[122:125]
    s_waitcnt vmcnt(10)
    v_mfma_f32_16x16x32_bf16 v[122:125], v[164:167], v[68:71], v[122:125]
    s_waitcnt vmcnt(9)
    v_mfma_f32_16x16x32_bf16 v[122:125], v[168:171], v[72:75], v[122:125]
    s_waitcnt vmcnt(8)
    v_mfma_f32_16x16x32_bf16 v[122:125], v[172:175], v[76:79], v[122:125]
    s_waitcnt vmcnt(7)
    v_mfma_f32_16x16x32_bf16 v[122:125], v[176:179], v[80:83], v[122:125]
    s_waitcnt vmcnt(6)
    v_mfma_f32_16x16x32_bf16 v[122:125], v[180:183], v[84:87], v[122:125]
    s_waitcnt vmcnt(5)
    v_mfma_f32_16x16x32_bf16 v[122:125], v[184:187], v[88:91], v[122:125]
    s_waitcnt vmcnt(4)
    v_mfma_f32_16x16x32_bf16 v[122:125], v[188:191], v[92:95], v[122:125]
    s_waitcnt vmcnt(3)
    v_mfma_f32_16x16x32_bf16 v[122:125], v[192:195], v[96:99], v[122:125]
    s_waitcnt vmcnt(2)
    v_mfma_f32_16x16x32_bf16 v[122:125], v[196:199], v[100:103], v[122:125]
    s_waitcnt vmcnt(1)
    v_mfma_f32_16x16x32_bf16 v[122:125], v[200:203], v[104:107], v[122:125]
    s_waitcnt vmcnt(0)
    v_mfma_f32_16x16x32_bf16 v[122:125], v[204:207], v[108:111], v[122:125]
    s_nop 7
    v_add_u32 v122, 0x800, v122
    v_add_u32 v123, 0x800, v123
    v_add_u32 v124, 0x800, v124
    v_add_u32 v125, 0x800, v125
    v_and_or_b32 v122, v122, v12, s44
    v_and_or_b32 v123, v123, v12, s45
    v_and_or_b32 v124, v124, v12, s46
    v_and_or_b32 v125, v125, v12, s47
    global_store_dwordx4 v126, v[122:125], s[60:61]
    s_add_u32 s60, s60, 0x40000
    s_addc_u32 s61, s61, 0
    global_store_dwordx4 v126, v[122:125], s[60:61] sc1
    s_setprio 0
    s_branch L_A_go
L_A_nos1:
    s_waitcnt lgkmcnt(0)
    s_load_dword s9, s[42:43], 0
    s_cmp_lg_u32 s8, 2
    s_cbranch_scc1 L_A_nogate
    s_sleep 8
    v_lshlrev_b32 v56, 4, v0
    v_lshlrev_b32 v57, 4, v1
    global_load_dwordx4 v[32:35], v56, s[16:17]
    global_load_dwordx4 v[36:39], v57, s[16:17] offset:1024
    global_load_dwordx4 v[40:43], v56, s[16:17] offset:1280
    global_load_dwordx4 v[44:47], v57, s[16:17] offset:2304
    global_load_dwordx4 v[48:51], v56, s[36:37]
    global_load_dwordx4 v[52:55], v57, s[36:37] offset:1024
    v_mov_b32 v58, 0
    v_mov_b32 v59, 0
    v_cmp_lt_u32 vcc, 15, v0
    s_waitcnt vmcnt(0)
    s_nop 0
    v_cndmask_b32 v52, v52, v58, vcc
    v_cndmask_b32 v53, v53, v58, vcc
    v_cndmask_b32 v54, v54, v58, vcc
    v_cndmask_b32 v55, v55, v58, vcc
    v_dot2_f32_bf16 v58, v32, v48, v58
    v_dot2_f32_bf16 v58, v33, v49, v58
    v_dot2_f32_bf16 v58, v34, v50, v58
    v_dot2_f32_bf16 v58, v35, v51, v58
    v_dot2_f32_bf16 v58, v36, v52, v58
    v_dot2_f32_bf16 v58, v37, v53, v58
    v_dot2_f32_bf16 v58, v38, v54, v58
    v_dot2_f32_bf16 v58, v39, v55, v58
    v_dot2_f32_bf16 v59, v40, v48, v59
    v_dot2_f32_bf16 v59, v41, v49, v59
    v_dot2_f32_bf16 v59, v42, v50, v59
    v_dot2_f32_bf16 v59, v43, v51, v59
    v_dot2_f32_bf16 v59, v44, v52, v59
    v_dot2_f32_bf16 v59, v45, v53, v59
    v_dot2_f32_bf16 v59, v46, v54, v59
    v_dot2_f32_bf16 v59, v47, v55, v59
    v_add_f32_dpp v58, v58, v58 quad_perm:[1,0,3,2] row_mask:0xf bank_mask:0xf
    s_nop 1
    v_add_f32_dpp v58, v58, v58 quad_perm:[2,3,0,1] row_mask:0xf bank_mask:0xf
    s_nop 1
    v_add_f32_dpp v58, v58, v58 row_half_mirror row_mask:0xf bank_mask:0xf
    s_nop 1
    v_add_f32_dpp v58, v58, v58 row_mirror row_mask:0xf bank_mask:0xf
    v_mov_b32 v60, v58
    s_nop 1
    v_permlane16_swap_b32 v58, v60
    v_add_f32 v58, v58, v60
    v_mov_b32 v60, v58
    s_nop 1
    v_permlane32_swap_b32 v58, v60
    v_add_f32 v58, v58, v60
    v_add_f32_dpp v59, v59, v59 quad_perm:[1,0,3,2] row_mask:0xf bank_mask:0xf
    s_nop 1
    v_add_f32_dpp v59, v59, v59 quad_perm:[2,3,0,1] row_mask:0xf bank_mask:0xf
    s_nop 1
    v_add_f32_dpp v59, v59, v59 row_half_mirror row_mask:0xf bank_mask:0xf
    s_nop 1
    v_add_f32_dpp v59, v59, v59 row_mirror row_mask:0xf bank_mask:0xf
    v_mov_b32 v60, v59
    s_nop 1
    v_permlane16_swap_b32 v59, v60
    v_add_f32 v59, v59, v60
    v_mov_b32 v60, v59
    s_nop 1
    v_permlane32_swap_b32 v59, v60
    v_add_f32 v59, v59, v60
    v_mul_f32 v58, 0xbfb8aa3b, v58
    v_exp_f32 v58, v58
    s_nop 0
    v_add_f32 v58, 1.0, v58
    v_rcp_f32 v58, v58
    v_mul_f32 v59, 0xbfb8aa3b, v59
    v_exp_f32 v59, v59
    s_nop 0
    v_add_f32 v59, 1.0, v59
    v_rcp_f32 v59, v59
    v_mov_b32 v60, 0x20000
    ds_write_b64 v60, v[58:59]
    s_waitcnt lgkmcnt(0)
L_A_nogate:
    s_sleep 6
L_A_go:
    v_lshrrev_b32 v196, 3, v0
    v_lshlrev_b32 v196, 10, v196
    v_and_b32 v4, 7, v0
    v_and_b32 v5, 1, v2
    v_lshlrev_b32 v5, 1, v5
    v_xor_b32 v4, v4, v5
    v_lshl_add_u32 v196, v4, 4, v196
    v_xor_b32 v197, 64, v196
    v_add_u32 v197, 7168, v197
    v_add_u32 v198, 14336, v196
    v_add_u32 v199, 14336, v197
    s_lshl_b32 s10, s51, 22
    s_lshl_b32 s11, s52, 20
    s_add_u32 s10, s10, s11
    s_lshl_b32 s11, s5, 17
    s_add_u32 s10, s10, s11
    s_lshl_b32 s11, s8, 7
    s_add_u32 s10, s10, s11
    s_lshl_b32 s11, s6, 16
    s_add_u32 s10, s10, s11
    s_add_u32 s56, s18, s10
    s_addc_u32 s57, s19, 0
    s_lshl_b32 s3, s6, 17
    s_sub_u32 s3, 32768, s3
    s_ashr_i32 s7, s3, 31
    s_getreg_b32 s53, hwreg(HW_REG_XCC_ID)
    s_and_b32 s53, s53, 0xf
    s_cmp_lg_u32 s8, 7
    s_cbranch_scc1 nopre_16
    v_lshlrev_b32 v3, 2, v0
    s_lshl_b32 s10, s4, 8
    s_add_u32 s10, s10, 0x2000
    s_add_u32 s12, s42, s10
    s_addc_u32 s13, s43, 0
    global_load_dword v8, v3, s[12:13] sc1
    s_waitcnt lgkmcnt(0)
    s_add_u32 s9, s9, 0x9e5
    s_and_b32 s44, s9, 0xfff
    s_add_u32 s45, s44, 0x155
    s_and_b32 s45, s45, 0xfff
    s_add_u32 s46, s44, 0x2aa
    s_and_b32 s46, s46, 0xfff
    s_add_u32 s47, s44, 0x3ff
    s_and_b32 s47, s47, 0xfff
    v_mov_b32 v192, 0xfffff000
    s_and_b32 s28, s9, 1
    s_mul_i32 s28, s28, 0x10001
    s_xor_b32 s29, s28, 1
    s_xor_b32 s40, s28, 0x10000
    s_xor_b32 s41, s28, 0x10001
    s_sub_u32 s9, s9, 0x9e5
    s_lshl_b32 s10, s53, 12
    s_or_b32 s10, s10, s44
    v_mov_b32 v4, s10
    v_mov_b32 v5, s45
    v_mov_b32 v6, s46
    v_mov_b32 v7, s47
    s_lshl_b32 s10, s15, 7
    s_lshl_b32 s11, s5, 4
    s_add_u32 s10, s10, s11
    s_add_u32 s10, s10, 0x1000
    s_add_u32 s12, s42, s10
    s_addc_u32 s13, s43, 0
    s_mov_b64 exec, 1
    global_store_dwordx4 v3, v[4:7], s[12:13] sc1
    s_mov_b64 exec, -1
    s_nop 0
nopre_16:
    global_load_lds_dwordx4 v196, s[56:57] offset:0
    global_load_lds_dwordx4 v197, s[56:57] offset:1024
    global_load_lds_dwordx4 v198, s[56:57] offset:2048
    global_load_lds_dwordx4 v199, s[56:57] offset:3072
    s_add_u32 s56, s56, 0x8000
    s_addc_u32 s57, s57, 0
    s_add_u32 m0, m0, 4096
    s_nop 0
    global_load_lds_dwordx4 v196, s[56:57] offset:0
    global_load_lds_dwordx4 v197, s[56:57] offset:1024
    s_barrier
    global_load_lds_dwordx4 v198, s[56:57] offset:2048
    global_load_lds_dwordx4 v199, s[56:57] offset:3072
    s_add_u32 s56, s56, s3
    s_addc_u32 s57, s57, s7
    s_add_u32 m0, m0, 4096
    s_barrier
    global_load_lds_dwordx4 v196, s[56:57] offset:0
    global_load_lds_dwordx4 v197, s[56:57] offset:1024
    global_load_lds_dwordx4 v198, s[56:57] offset:2048
    global_load_lds_dwordx4 v199, s[56:57] offset:3072
    s_add_u32 s56, s56, 0x8000
    s_addc_u32 s57, s57, 0
    s_add_u32 m0, m0, 4096
    s_nop 0
    global_load_lds_dwordx4 v196, s[56:57] offset:0
    global_load_lds_dwordx4 v197, s[56:57] offset:1024
    global_load_lds_dwordx4 v198, s[56:57] offset:2048
    global_load_lds_dwordx4 v199, s[56:57] offset:3072
    v_lshrrev_b32 v3, 1, v1
    v_and_b32 v3, 4, v3
    v_and_b32 v4, 2, v1
    v_or_b32 v3, v3, v4
    v_xor_b32 v3, v3, v2
    v_lshlrev_b32 v3, 4, v3
    v_lshl_add_u32 v193, v1, 7, v3
    v_add_u32 v193, s14, v193
    v_xor_b32 v194, 64, v193
    v_lshrrev_b32 v3, 2, v1
    v_lshl_add_u32 v3, v2, 3, v3
    v_lshlrev_b32 v3, 7, v3
    v_lshrrev_b32 v4, 2, v0
    v_and_b32 v4, 6, v4
    v_bfe_u32 v5, v0, 1, 1
    v_or_b32 v4, v4, v5
    v_lshl_add_u32 v3, v4, 4, v3
    v_and_b32 v5, 1, v0
    v_lshl_add_u32 v3, v5, 3, v3
    v_add_u32 v200, s14, v3
    v_xor_b32 v201, 32, v200
    v_xor_b32 v202, 64, v200
    v_xor_b32 v203, 96, v200
    s_waitcnt lgkmcnt(0)
    s_add_u32 s9, s9, 0x9e5
    s_and_b32 s44, s9, 0xfff
    s_add_u32 s45, s44, 0x155
    s_and_b32 s45, s45, 0xfff
    s_add_u32 s46, s44, 0x2aa
    s_and_b32 s46, s46, 0xfff
    s_add_u32 s47, s44, 0x3ff
    s_and_b32 s47, s47, 0xfff
    v_mov_b32 v192, 0xfffff000
    s_and_b32 s28, s9, 1
    s_mul_i32 s28, s28, 0x10001
    s_xor_b32 s29, s28, 1
    s_xor_b32 s40, s28, 0x10000
    s_xor_b32 s41, s28, 0x10001
    v_lshlrev_b32 v3, 6, v1
    v_lshl_add_u32 v3, v2, 4, v3
    s_lshl_b32 s10, s51, 15
    s_lshl_b32 s11, s6, 14
    s_add_u32 s10, s10, s11
    s_lshl_b32 s11, s8, 11
    s_add_u32 s10, s10, s11
    s_add_u32 s10, s10, 0x20000
    s_add_u32 s58, s42, s10
    s_addc_u32 s59, s43, 0
    v_mul_u32_u24 v204, 528, v1
    v_lshl_add_u32 v204, v2, 4, v204
    v_add_u32 v204, s14, v204
    v_lshrrev_b32 v7, 5, v0
    s_lshl_b32 s10, s8, 1
    v_add_u32 v7, s10, v7
    v_and_b32 v6, 31, v0
    v_mul_u32_u24 v4, 528, v7
    v_lshl_add_u32 v4, v6, 4, v4
    v_add_u32 v5, 0x10000, v4
    v_mul_u32_u24 v7, 272, v7
    v_lshl_add_u32 v6, v6, 3, v7
    v_add_u32 v6, 8576, v6
    v_mul_u32_u24 v7, 272, v1
    v_lshl_add_u32 v7, v2, 4, v7
    v_add_u32 v7, 8576, v7
    v_lshlrev_b32 v205, 6, v1
    v_lshl_add_u32 v205, v2, 4, v205
    s_lshl_b32 s10, s15, 17
    s_lshl_b32 s11, s5, 14
    s_add_u32 s10, s10, s11
    s_lshl_b32 s11, s8, 11
    s_add_u32 s10, s10, s11
    s_add_u32 s10, s10, 0x400000
    s_add_u32 s60, s42, s10
    s_addc_u32 s61, s43, 0
    s_lshl_b32 s10, s15, 11
    s_lshl_b32 s11, s8, 8
    s_add_u32 s10, s10, s11
    s_lshl_b32 s11, s5, 4
    s_add_u32 s10, s10, s11
    s_add_u32 s10, s10, 0x8000
    s_add_u32 s62, s42, s10
    s_addc_u32 s63, s43, 0
    v_lshrrev_b32 v206, 5, v0
    v_lshlrev_b32 v206, 7, v206
    v_mov_b32 v236, 0x07060302
    v_mov_b32 v237, 0xfffefffe
    v_lshrrev_b32 v212, 5, v0
    v_lshlrev_b32 v212, 10, v212
    v_and_b32 v220, 31, v0
    v_lshl_add_u32 v212, v220, 2, v212
    v_add_u32 v213, 16384, v212
    v_add_u32 v214, 32768, v212
    v_add_u32 v215, 49152, v212
    v_add_u32 v216, 65536, v212
    v_add_u32 v217, 81920, v212
    v_add_u32 v218, 98304, v212
    v_add_u32 v219, 114688, v212
    v_and_b32 v220, 7, v0
    v_lshlrev_b32 v220, 4, v220
    v_and_b32 v222, 1, v2
    v_lshl_add_u32 v220, v222, 7, v220
    s_lshl_b32 s10, s15, 17
    s_lshl_b32 s11, s5, 7
    s_add_u32 s10, s10, s11
    s_lshl_b32 s11, s8, 11
    s_add_u32 s10, s10, s11
    s_add_u32 s10, s10, 0x400000
    s_add_u32 s96, s42, s10
    s_addc_u32 s97, s43, 0
    s_lshl_b32 s10, s15, 11
    s_lshl_b32 s11, s5, 8
    s_add_u32 s10, s10, s11
    s_add_u32 s10, s10, 0x8000
    s_add_u32 s98, s42, s10
    s_addc_u32 s99, s43, 0
    v_lshlrev_b32 v221, 13, v222
    v_lshrrev_b32 v223, 5, v0
    v_lshl_add_u32 v221, v223, 9, v221
    v_bfe_u32 v223, v0, 1, 1
    v_lshl_add_u32 v221, v223, 5, v221
    v_bfe_u32 v223, v0, 2, 2
    v_lshl_add_u32 v221, v223, 3, v221
    v_and_b32 v223, 1, v0
    v_lshl_add_u32 v221, v223, 2, v221
    v_lshlrev_b32 v222, 7, v222
    v_and_b32 v223, 3, v0
    v_and_b32 v238, 1, v223
    v_lshrrev_b32 v242, 1, v223
    v_lshl_or_b32 v238, v242, 16, v238
    v_xor_b32 v238, s28, v238
    v_xor_b32 v239, 0x10001, v238
    v_bfe_u32 v223, v221, 2, 2
    v_and_b32 v240, 1, v223
    v_lshrrev_b32 v242, 1, v223
    v_lshl_or_b32 v240, v242, 16, v240
    v_xor_b32 v240, s28, v240
    v_xor_b32 v241, 0x10001, v240
    s_lshl_b32 s100, s51, 2
    s_add_u32 s100, s100, s52
    s_lshl_b32 s101, s6, 3
    s_add_u32 s101, s101, s5
    s_waitcnt vmcnt(12)
    ds_read_b128 v[8:11], v193 offset:0
    ds_read_b128 v[12:15], v194 offset:0
    ds_read_b128 v[16:19], v193 offset:2048
    ds_read_b128 v[20:23], v194 offset:2048
    ds_read_b64_tr_b16 v[72:73], v200 offset:0
    ds_read_b64_tr_b16 v[74:75], v200 offset:512
    ds_read_b64_tr_b16 v[88:89], v201 offset:0
    ds_read_b64_tr_b16 v[90:91], v201 offset:512
    ds_read_b64_tr_b16 v[104:105], v202 offset:0
    ds_read_b64_tr_b16 v[106:107], v202 offset:512
    ds_read_b64_tr_b16 v[120:121], v203 offset:0
    ds_read_b64_tr_b16 v[122:123], v203 offset:512
    s_waitcnt vmcnt(8)
    ds_read_b128 v[24:27], v193 offset:4096
    ds_read_b128 v[28:31], v194 offset:4096
    ds_read_b128 v[32:35], v193 offset:6144
    ds_read_b128 v[36:39], v194 offset:6144
    ds_read_b64_tr_b16 v[76:77], v200 offset:4096
    ds_read_b64_tr_b16 v[78:79], v200 offset:4608
    ds_read_b64_tr_b16 v[92:93], v201 offset:4096
    ds_read_b64_tr_b16 v[94:95], v201 offset:4608
    ds_read_b64_tr_b16 v[108:109], v202 offset:4096
    ds_read_b64_tr_b16 v[110:111], v202 offset:4608
    ds_read_b64_tr_b16 v[124:125], v203 offset:4096
    ds_read_b64_tr_b16 v[126:127], v203 offset:4608
    s_waitcnt vmcnt(4)
    ds_read_b128 v[40:43], v193 offset:8192
    ds_read_b128 v[44:47], v194 offset:8192
    ds_read_b128 v[48:51], v193 offset:10240
    ds_read_b128 v[52:55], v194 offset:10240
    ds_read_b64_tr_b16 v[80:81], v200 offset:8192
    ds_read_b64_tr_b16 v[82:83], v200 offset:8704
    ds_read_b64_tr_b16 v[96:97], v201 offset:8192
    ds_read_b64_tr_b16 v[98:99], v201 offset:8704
    ds_read_b64_tr_b16 v[112:113], v202 offset:8192
    ds_read_b64_tr_b16 v[114:115], v202 offset:8704
    ds_read_b64_tr_b16 v[128:129], v203 offset:8192
    ds_read_b64_tr_b16 v[130:131], v203 offset:8704
    s_waitcnt vmcnt(0)
    ds_read_b128 v[56:59], v193 offset:12288
    ds_read_b128 v[60:63], v194 offset:12288
    ds_read_b128 v[64:67], v193 offset:14336
    ds_read_b128 v[68:71], v194 offset:14336
    ds_read_b64_tr_b16 v[84:85], v200 offset:12288
    ds_read_b64_tr_b16 v[86:87], v200 offset:12800
    ds_read_b64_tr_b16 v[100:101], v201 offset:12288
    ds_read_b64_tr_b16 v[102:103], v201 offset:12800
    ds_read_b64_tr_b16 v[116:117], v202 offset:12288
    ds_read_b64_tr_b16 v[118:119], v202 offset:12800
    ds_read_b64_tr_b16 v[132:133], v203 offset:12288
    ds_read_b64_tr_b16 v[134:135], v203 offset:12800
    v_and_b32 v196, 7, v0
    v_lshlrev_b32 v196, 4, v196
    s_lshl_b32 s10, s15, 7
    s_add_u32 s10, s10, 0x1000
    s_add_u32 s54, s42, s10
    s_addc_u32 s55, s43, 0
    s_cmp_lg_u32 s8, 0
    s_cbranch_scc1 hwd_18
    v_lshlrev_b32 v140, 4, v1
    s_lshl_b32 s10, s4, 8
    s_add_u32 s10, s10, 0x2000
    s_add_u32 s12, s42, s10
    s_addc_u32 s13, s43, 0
    s_movk_i32 s49, 100
    s_mov_b64 exec, 0xffff
hw_17:
    global_load_dwordx4 v[136:139], v140, s[12:13] sc1
    s_waitcnt vmcnt(0)
    v_xor_b32 v141, s44, v136
    v_bitop3_b32 v141, v141, v137, s45 bitop3:0xf6
    v_bitop3_b32 v141, v141, v138, s46 bitop3:0xf6
    v_bitop3_b32 v141, v141, v139, s47 bitop3:0xf6
    v_and_b32 v141, s48, v141
    v_cmp_ne_u32 vcc, 0, v141
    s_cbranch_vccz hwd_18
    s_sleep 1
    s_sub_u32 s49, s49, 1
    s_cbranch_scc0 hw_17
    s_nop 0
hwd_18:
    s_mov_b64 exec, -1
    s_barrier
    s_mov_b32 s49, 300000
    global_load_dwordx4 v[152:155], v3, s[58:59] offset:0 sc1
    global_load_dwordx4 v[156:159], v3, s[58:59] offset:1024 sc1
    global_load_dwordx4 v[208:211], v196, s[54:55] sc1
poll_19:
    s_waitcnt vmcnt(0)
    v_xor_b32 v152, s28, v152
    v_xor_b32 v153, s29, v153
    v_xor_b32 v154, s40, v154
    v_xor_b32 v155, s41, v155
    v_xor_b32 v156, s28, v156
    v_xor_b32 v157, s29, v157
    v_xor_b32 v158, s40, v158
    v_xor_b32 v159, s41, v159
    v_or_b32 v195, v152, v153
    v_or3_b32 v195, v195, v154, v155
    v_or3_b32 v195, v195, v156, v157
    v_or3_b32 v195, v195, v158, v159
    v_and_b32 v195, 0x10001, v195
    v_xor_b32 v197, s44, v208
    v_bitop3_b32 v197, v197, v209, s45 bitop3:0xf6
    v_bitop3_b32 v197, v197, v210, s46 bitop3:0xf6
    v_bitop3_b32 v197, v197, v211, s47 bitop3:0xf6
    v_and_or_b32 v195, v197, s48, v195
    v_cmp_ne_u32 vcc, 0, v195
    s_cbranch_vccz pdone_20
    s_sub_u32 s49, s49, 1
    s_cbranch_scc1 pdone_20
    s_or_b32 s10, vcc_lo, vcc_hi
    s_lshr_b32 s11, s10, 16
    s_or_b32 s10, s10, s11
    s_and_b32 s10, s10, 0xffff
    s_mul_i32 s10, s10, 0x10001
    s_mov_b32 exec_lo, s10
    s_mov_b32 exec_hi, s10
    s_sleep 1
    global_load_dwordx4 v[152:155], v3, s[58:59] offset:0 sc1
    global_load_dwordx4 v[156:159], v3, s[58:59] offset:1024 sc1
    global_load_dwordx4 v[208:211], v196, s[54:55] sc1
    s_branch poll_19
pdone_20:
    s_mov_b64 exec, -1
    s_waitcnt lgkmcnt(0)
    v_mfma_f32_16x16x32_bf16 v[160:163], v[8:11], v[152:155], 0
    v_mfma_f32_16x16x32_bf16 v[160:163], v[12:15], v[156:159], v[160:163]
    v_mfma_f32_16x16x32_bf16 v[164:167], v[16:19], v[152:155], 0
    v_mfma_f32_16x16x32_bf16 v[164:167], v[20:23], v[156:159], v[164:167]
    v_lshrrev_b32 v208, 12, v208
    v_cmp_ne_u32 vcc, s53, v208
    v_mfma_f32_16x16x32_bf16 v[168:171], v[24:27], v[152:155], 0
    v_mfma_f32_16x16x32_bf16 v[168:171], v[28:31], v[156:159], v[168:171]
    s_cmp_eq_u64 vcc, 0
    s_cselect_b32 s50, 3, 1
    v_mfma_f32_16x16x32_bf16 v[172:175], v[32:35], v[152:155], 0
    v_mfma_f32_16x16x32_bf16 v[172:175], v[36:39], v[156:159], v[172:175]
    ds_write_b128 v204, v[160:163] offset:0
    v_mfma_f32_16x16x32_bf16 v[176:179], v[40:43], v[152:155], 0
    v_mfma_f32_16x16x32_bf16 v[176:179], v[44:47], v[156:159], v[176:179]
    ds_write_b128 v204, v[164:167] offset:64
    v_mfma_f32_16x16x32_bf16 v[180:183], v[48:51], v[152:155], 0
    v_mfma_f32_16x16x32_bf16 v[180:183], v[52:55], v[156:159], v[180:183]
    ds_write_b128 v204, v[168:171] offset:128
    v_mfma_f32_16x16x32_bf16 v[184:187], v[56:59], v[152:155], 0
    v_mfma_f32_16x16x32_bf16 v[184:187], v[60:63], v[156:159], v[184:187]
    ds_write_b128 v204, v[172:175] offset:192
    v_mfma_f32_16x16x32_bf16 v[188:191], v[64:67], v[152:155], 0
    v_mfma_f32_16x16x32_bf16 v[188:191], v[68:71], v[156:159], v[188:191]
    ds_write_b128 v204, v[176:179] offset:256
    s_nop 0
    ds_write_b128 v204, v[180:183] offset:320
    s_nop 1
    ds_write_b128 v204, v[184:187] offset:384
    s_nop 1
    ds_write_b128 v204, v[188:191] offset:448
    s_waitcnt lgkmcnt(0)
    s_barrier
    ds_read_b128 v[160:163], v4 offset:0
    ds_read_b128 v[164:167], v4 offset:16384
    ds_read_b128 v[168:171], v4 offset:32768
    ds_read_b128 v[172:175], v4 offset:49152
    ds_read_b128 v[176:179], v5 offset:0
    ds_read_b128 v[180:183], v5 offset:16384
    ds_read_b128 v[184:187], v5 offset:32768
    ds_read_b128 v[188:191], v5 offset:49152
    s_waitcnt lgkmcnt(6)
    v_pk_add_f32 v[160:161], v[160:161], v[164:165]
    v_pk_add_f32 v[162:163], v[162:163], v[166:167]
    s_waitcnt lgkmcnt(4)
    v_pk_add_f32 v[168:169], v[168:169], v[172:173]
    v_pk_add_f32 v[170:171], v[170:171], v[174:175]
    v_pk_add_f32 v[160:161], v[160:161], v[168:169]
    v_pk_add_f32 v[162:163], v[162:163], v[170:171]
    s_waitcnt lgkmcnt(2)
    v_pk_add_f32 v[176:177], v[176:177], v[180:181]
    v_pk_add_f32 v[178:179], v[178:179], v[182:183]
    s_waitcnt lgkmcnt(0)
    v_pk_add_f32 v[184:185], v[184:185], v[188:189]
    v_pk_add_f32 v[186:187], v[186:187], v[190:191]
    v_pk_add_f32 v[176:177], v[176:177], v[184:185]
    v_pk_add_f32 v[178:179], v[178:179], v[186:187]
    v_pk_add_f32 v[160:161], v[160:161], v[176:177]
    v_pk_add_f32 v[162:163], v[162:163], v[178:179]
    v_max_f32 v196, v160, v161
    v_max3_f32 v196, v196, v162, v163
    s_nop 1
    v_max_f32_dpp v196, v196, v196 quad_perm:[1,0,3,2] row_mask:0xf bank_mask:0xf
    s_nop 1
    v_max_f32_dpp v196, v196, v196 quad_perm:[2,3,0,1] row_mask:0xf bank_mask:0xf
    s_nop 1
    v_max_f32_dpp v196, v196, v196 row_half_mirror row_mask:0xf bank_mask:0xf
    s_nop 1
    v_max_f32_dpp v196, v196, v196 row_mirror row_mask:0xf bank_mask:0xf
    v_mov_b32 v197, v196
    s_nop 1
    v_permlane16_swap_b32 v196, v197
    v_max_f32 v196, v196, v197
    v_sub_f32 v160, v160, v196
    v_sub_f32 v161, v161, v196
    v_sub_f32 v162, v162, v196
    v_sub_f32 v163, v163, v196
    v_exp_f32 v160, v160
    v_exp_f32 v161, v161
    v_exp_f32 v162, v162
    v_exp_f32 v163, v163
    v_cvt_pk_bf16_f32 v198, v160, v161
    v_cvt_pk_bf16_f32 v199, v162, v163
    ds_write_b64 v6, v[198:199]
    s_waitcnt lgkmcnt(0)
    s_barrier
    ds_read_b128 v[8:11], v7 offset:0
    ds_read_b128 v[12:15], v7 offset:64
    ds_read_b128 v[16:19], v7 offset:128
    ds_read_b128 v[20:23], v7 offset:192
    v_lshlrev_b32 v168, 16, v198
    v_and_b32 v169, 0xffff0000, v198
    v_lshlrev_b32 v170, 16, v199
    v_and_b32 v171, 0xffff0000, v199
    v_add_f32 v168, v168, v169
    v_add_f32 v170, v170, v171
    v_add_f32 v168, v168, v170
    s_mov_b32 s10, 1
    s_mov_b32 s11, 1
    v_add_f32_dpp v168, v168, v168 quad_perm:[1,0,3,2] row_mask:0xf bank_mask:0xf
    s_nop 1
    v_add_f32_dpp v168, v168, v168 quad_perm:[2,3,0,1] row_mask:0xf bank_mask:0xf
    s_nop 1
    v_add_f32_dpp v168, v168, v168 row_half_mirror row_mask:0xf bank_mask:0xf
    s_nop 1
    v_add_f32_dpp v168, v168, v168 row_mirror row_mask:0xf bank_mask:0xf
    v_mov_b32 v169, v168
    s_nop 1
    v_permlane16_swap_b32 v168, v169
    v_add_f32 v168, v168, v169
    s_cmp_eq_u32 s50, 3
    s_cbranch_scc0 sg_22
    s_waitcnt lgkmcnt(3)
    v_mfma_f32_16x16x32_bf16 v[136:139], v[72:75], v[8:11], 0
    v_and_or_b32 v152, v196, v192, s44
    v_lshlrev_b32 v153, 12, v196
    s_waitcnt lgkmcnt(2)
    v_mfma_f32_16x16x32_bf16 v[136:139], v[76:79], v[12:15], v[136:139]
    v_or_b32 v153, s45, v153
    v_add_u32 v154, 0x800, v168
    s_waitcnt lgkmcnt(1)
    v_mfma_f32_16x16x32_bf16 v[136:139], v[80:83], v[16:19], v[136:139]
    v_and_or_b32 v154, v154, v192, s46
    v_mov_b32 v155, s47
    s_waitcnt lgkmcnt(0)
    v_mfma_f32_16x16x32_bf16 v[136:139], v[84:87], v[20:23], v[136:139]
    s_mov_b64 exec, s[10:11]
    global_store_dwordx4 v206, v[152:155], s[62:63]
    s_mov_b64 exec, -1
    v_mfma_f32_16x16x32_bf16 v[140:143], v[88:91], v[8:11], 0
    v_mfma_f32_16x16x32_bf16 v[140:143], v[92:95], v[12:15], v[140:143]
    v_mfma_f32_16x16x32_bf16 v[140:143], v[96:99], v[16:19], v[140:143]
    v_mfma_f32_16x16x32_bf16 v[140:143], v[100:103], v[20:23], v[140:143]
    v_mfma_f32_16x16x32_bf16 v[144:147], v[104:107], v[8:11], 0
    v_mfma_f32_16x16x32_bf16 v[144:147], v[108:111], v[12:15], v[144:147]
    v_mfma_f32_16x16x32_bf16 v[144:147], v[112:115], v[16:19], v[144:147]
    v_perm_b32 v176, v137, v136, v236
    v_perm_b32 v177, v139, v138, v236
    s_nop 2
    v_perm_b32 v178, v141, v140, v236
    v_mfma_f32_16x16x32_bf16 v[144:147], v[116:119], v[20:23], v[144:147]
    v_perm_b32 v179, v143, v142, v236
    v_pk_add_u16 v176, v176, 1 op_sel_hi:[1,0]
    v_pk_add_u16 v177, v177, 1 op_sel_hi:[1,0]
    v_mfma_f32_16x16x32_bf16 v[148:151], v[120:123], v[8:11], 0
    v_pk_add_u16 v178, v178, 1 op_sel_hi:[1,0]
    v_pk_add_u16 v179, v179, 1 op_sel_hi:[1,0]
    v_and_or_b32 v176, v176, v237, s28
    v_mfma_f32_16x16x32_bf16 v[148:151], v[124:127], v[12:15], v[148:151]
    v_and_or_b32 v177, v177, v237, s29
    v_and_or_b32 v178, v178, v237, s40
    v_and_or_b32 v179, v179, v237, s41
    v_mfma_f32_16x16x32_bf16 v[148:151], v[128:131], v[16:19], v[148:151]
    global_store_dwordx4 v205, v[176:179], s[60:61] offset:0
    v_mfma_f32_16x16x32_bf16 v[148:151], v[132:135], v[20:23], v[148:151]
    v_perm_b32 v180, v145, v144, v236
    v_perm_b32 v181, v147, v146, v236
    s_nop 5
    v_perm_b32 v182, v149, v148, v236
    v_perm_b32 v183, v151, v150, v236
    v_pk_add_u16 v180, v180, 1 op_sel_hi:[1,0]
    v_pk_add_u16 v181, v181, 1 op_sel_hi:[1,0]
    v_pk_add_u16 v182, v182, 1 op_sel_hi:[1,0]
    v_pk_add_u16 v183, v183, 1 op_sel_hi:[1,0]
    v_and_or_b32 v180, v180, v237, s28
    v_and_or_b32 v181, v181, v237, s29
    v_and_or_b32 v182, v182, v237, s40
    v_and_or_b32 v183, v183, v237, s41
    global_store_dwordx4 v205, v[180:183], s[60:61] offset:1024
    s_nop 0
    s_branch sd_23
sg_22:
    s_waitcnt lgkmcnt(3)
    v_mfma_f32_16x16x32_bf16 v[136:139], v[72:75], v[8:11], 0
    v_and_or_b32 v152, v196, v192, s44
    v_lshlrev_b32 v153, 12, v196
    s_waitcnt lgkmcnt(2)
    v_mfma_f32_16x16x32_bf16 v[136:139], v[76:79], v[12:15], v[136:139]
    v_or_b32 v153, s45, v153
    v_add_u32 v154, 0x800, v168
    s_waitcnt lgkmcnt(1)
    v_mfma_f32_16x16x32_bf16 v[136:139], v[80:83], v[16:19], v[136:139]
    v_and_or_b32 v154, v154, v192, s46
    v_mov_b32 v155, s47
    s_waitcnt lgkmcnt(0)
    v_mfma_f32_16x16x32_bf16 v[136:139], v[84:87], v[20:23], v[136:139]
    s_mov_b64 exec, s[10:11]
    global_store_dwordx4 v206, v[152:155], s[62:63] sc1
    s_mov_b64 exec, -1
    v_mfma_f32_16x16x32_bf16 v[140:143], v[88:91], v[8:11], 0
    v_mfma_f32_16x16x32_bf16 v[140:143], v[92:95], v[12:15], v[140:143]
    v_mfma_f32_16x16x32_bf16 v[140:143], v[96:99], v[16:19], v[140:143]
    v_mfma_f32_16x16x32_bf16 v[140:143], v[100:103], v[20:23], v[140:143]
    v_mfma_f32_16x16x32_bf16 v[144:147], v[104:107], v[8:11], 0
    v_mfma_f32_16x16x32_bf16 v[144:147], v[108:111], v[12:15], v[144:147]
    v_mfma_f32_16x16x32_bf16 v[144:147], v[112:115], v[16:19], v[144:147]
    v_perm_b32 v176, v137, v136, v236
    v_perm_b32 v177, v139, v138, v236
    s_nop 2
    v_perm_b32 v178, v141, v140, v236
    v_mfma_f32_16x16x32_bf16 v[144:147], v[116:119], v[20:23], v[144:147]
    v_perm_b32 v179, v143, v142, v236
    v_pk_add_u16 v176, v176, 1 op_sel_hi:[1,0]
    v_pk_add_u16 v177, v177, 1 op_sel_hi:[1,0]
    v_mfma_f32_16x16x32_bf16 v[148:151], v[120:123], v[8:11], 0
    v_pk_add_u16 v178, v178, 1 op_sel_hi:[1,0]
    v_pk_add_u16 v179, v179, 1 op_sel_hi:[1,0]
    v_and_or_b32 v176, v176, v237, s28
    v_mfma_f32_16x16x32_bf16 v[148:151], v[124:127], v[12:15], v[148:151]
    v_and_or_b32 v177, v177, v237, s29
    v_and_or_b32 v178, v178, v237, s40
    v_and_or_b32 v179, v179, v237, s41
    v_mfma_f32_16x16x32_bf16 v[148:151], v[128:131], v[16:19], v[148:151]
    global_store_dwordx4 v205, v[176:179], s[60:61] offset:0 sc1
    v_mfma_f32_16x16x32_bf16 v[148:151], v[132:135], v[20:23], v[148:151]
    v_perm_b32 v180, v145, v144, v236
    v_perm_b32 v181, v147, v146, v236
    s_nop 5
    v_perm_b32 v182, v149, v148, v236
    v_perm_b32 v183, v151, v150, v236
    v_pk_add_u16 v180, v180, 1 op_sel_hi:[1,0]
    v_pk_add_u16 v181, v181, 1 op_sel_hi:[1,0]
    v_pk_add_u16 v182, v182, 1 op_sel_hi:[1,0]
    v_pk_add_u16 v183, v183, 1 op_sel_hi:[1,0]
    v_and_or_b32 v180, v180, v237, s28
    v_and_or_b32 v181, v181, v237, s29
    v_and_or_b32 v182, v182, v237, s40
    v_and_or_b32 v183, v183, v237, s41
    global_store_dwordx4 v205, v[180:183], s[60:61] offset:1024 sc1
    s_nop 1
sd_23:
    s_lshl_b32 s10, s101, 14
    s_lshl_b32 s11, s8, 10
    s_add_u32 s10, s10, s11
    s_lshl_b32 s11, s100, 6
    s_add_u32 s10, s10, s11
    s_add_u32 s10, s10, 0x140000
    s_add_u32 s12, s42, s10
    s_addc_u32 s13, s43, 0
    s_lshl_b32 s10, s101, 8
    s_lshl_b32 s11, s100, 4
    s_add_u32 s10, s10, s11
    s_add_u32 s10, s10, 0x10000
    s_add_u32 s52, s42, s10
    s_addc_u32 s53, s43, 0
    s_sleep 4
    s_mov_b32 s49, 300000
poll_24:
    global_load_dword v8, v212, s[96:97] sc1
    global_load_dword v9, v213, s[96:97] sc1
    global_load_dword v10, v214, s[96:97] sc1
    global_load_dword v11, v215, s[96:97] sc1
    global_load_dword v12, v216, s[96:97] sc1
    global_load_dword v13, v217, s[96:97] sc1
    global_load_dword v14, v218, s[96:97] sc1
    global_load_dword v15, v219, s[96:97] sc1
    global_load_dwordx4 v[24:27], v220, s[98:99] sc1
    s_waitcnt vmcnt(0)
    v_xor_b32 v8, v238, v8
    v_xor_b32 v9, v238, v9
    v_xor_b32 v10, v238, v10
    v_xor_b32 v11, v238, v11
    v_xor_b32 v12, v238, v12
    v_xor_b32 v13, v238, v13
    v_xor_b32 v14, v238, v14
    v_xor_b32 v15, v238, v15
    v_or_b32 v29, v8, v9
    v_or3_b32 v29, v29, v10, v11
    v_or3_b32 v29, v29, v12, v13
    v_or3_b32 v29, v29, v14, v15
    v_and_b32 v29, 0x10001, v29
    v_xor_b32 v30, s44, v24
    v_bitop3_b32 v30, v30, v25, s45 bitop3:0xf6
    v_bitop3_b32 v30, v30, v26, s46 bitop3:0xf6
    v_bitop3_b32 v30, v30, v27, s47 bitop3:0xf6
    v_and_or_b32 v30, v30, s48, v29
    v_cmp_ne_u32 vcc, 0, v30
    s_cbranch_vccz pdone_25
    s_sub_u32 s49, s49, 1
    s_cbranch_scc0 poll_24
    s_nop 1
pdone_25:
    v_lshrrev_b32 v25, 12, v25
    v_bfi_b32 v24, s48, v25, v24
    s_nop 1
    v_max_f32_dpp v31, v24, v24 quad_perm:[1,0,3,2] row_mask:0xf bank_mask:0xf
    v_xor_b32 v26, s46, v26
    v_mov_b32 v32, 0
    v_max_f32_dpp v31, v31, v31 quad_perm:[2,3,0,1] row_mask:0xf bank_mask:0xf
    v_mov_b32 v33, 0
    v_mov_b32 v34, 0
    v_max_f32_dpp v31, v31, v31 row_half_mirror row_mask:0xf bank_mask:0xf
    v_mov_b32 v35, 0
    v_sub_f32 v24, v24, v31
    v_exp_f32 v24, v24
    v_lshlrev_b32 v16, 16, v8
    v_and_b32 v8, 0xffff0000, v8
    v_lshlrev_b32 v17, 16, v9
    v_and_b32 v9, 0xffff0000, v9
    v_lshlrev_b32 v18, 16, v10
    v_and_b32 v10, 0xffff0000, v10
    v_lshlrev_b32 v19, 16, v11
    v_and_b32 v11, 0xffff0000, v11
    v_lshlrev_b32 v20, 16, v12
    v_and_b32 v12, 0xffff0000, v12
    v_lshlrev_b32 v21, 16, v13
    v_and_b32 v13, 0xffff0000, v13
    v_lshlrev_b32 v22, 16, v14
    v_and_b32 v14, 0xffff0000, v14
    v_lshlrev_b32 v23, 16, v15
    v_and_b32 v15, 0xffff0000, v15
    v_mul_f32 v26, v26, v24
    v_fmac_f32_dpp v32, v24, v16 row_newbcast:0 row_mask:0xf bank_mask:0xf
    v_fmac_f32_dpp v33, v24, v8 row_newbcast:0 row_mask:0xf bank_mask:0xf
    v_fmac_f32_dpp v34, v24, v17 row_newbcast:1 row_mask:0xf bank_mask:0xf
    v_fmac_f32_dpp v35, v24, v9 row_newbcast:1 row_mask:0xf bank_mask:0xf
    v_fmac_f32_dpp v32, v24, v18 row_newbcast:2 row_mask:0xf bank_mask:0xf
    v_fmac_f32_dpp v33, v24, v10 row_newbcast:2 row_mask:0xf bank_mask:0xf
    v_fmac_f32_dpp v34, v24, v19 row_newbcast:3 row_mask:0xf bank_mask:0xf
    v_fmac_f32_dpp v35, v24, v11 row_newbcast:3 row_mask:0xf bank_mask:0xf
    v_fmac_f32_dpp v32, v24, v20 row_newbcast:4 row_mask:0xf bank_mask:0xf
    v_fmac_f32_dpp v33, v24, v12 row_newbcast:4 row_mask:0xf bank_mask:0xf
    v_fmac_f32_dpp v34, v24, v21 row_newbcast:5 row_mask:0xf bank_mask:0xf
    v_fmac_f32_dpp v35, v24, v13 row_newbcast:5 row_mask:0xf bank_mask:0xf
    v_fmac_f32_dpp v32, v24, v22 row_newbcast:6 row_mask:0xf bank_mask:0xf
    v_fmac_f32_dpp v33, v24, v14 row_newbcast:6 row_mask:0xf bank_mask:0xf
    v_fmac_f32_dpp v34, v24, v23 row_newbcast:7 row_mask:0xf bank_mask:0xf
    v_fmac_f32_dpp v35, v24, v15 row_newbcast:7 row_mask:0xf bank_mask:0xf
    v_pk_add_f32 v[32:33], v[32:33], v[34:35]
    v_perm_b32 v32, v33, v32, v236
    v_pk_add_u16 v32, v32, 1 op_sel_hi:[1,0]
    v_and_or_b32 v32, v32, v237, v240
    global_store_dword v221, v32, s[12:13] sc1
    s_cmp_lg_u32 s8, 0
    s_cbranch_scc1 skipml_26
    v_add_f32_dpp v26, v26, v26 quad_perm:[1,0,3,2] row_mask:0xf bank_mask:0xf
    s_nop 1
    v_add_f32_dpp v26, v26, v26 quad_perm:[2,3,0,1] row_mask:0xf bank_mask:0xf
    s_nop 1
    v_add_f32_dpp v26, v26, v26 row_half_mirror row_mask:0xf bank_mask:0xf
    v_and_or_b32 v12, v31, v192, s44
    v_lshlrev_b32 v13, 12, v31
    v_or_b32 v13, s45, v13
    v_add_u32 v14, 0x800, v26
    v_and_or_b32 v14, v14, v192, s46
    v_mov_b32 v15, s47
    s_mov_b64 exec, 0x10001
    global_store_dwordx4 v222, v[12:15], s[52:53] sc1
    s_mov_b64 exec, -1
    s_nop 0
skipml_26:
    s_barrier
    s_cmp_lg_u32 s8, 1
    s_cbranch_scc1 nohint_27
    s_bfe_u32 s51, s2, 0x40003
    s_lshl_b32 s10, s4, 8
    s_lshl_b32 s11, s51, 4
    s_add_u32 s10, s10, s11
    s_add_u32 s10, s10, 0x3000
    s_add_u32 s12, s42, s10
    s_addc_u32 s13, s43, 0
    v_mov_b32 v40, s44
    v_mov_b32 v41, s45
    v_mov_b32 v42, s46
    v_mov_b32 v43, s47
    v_mov_b32 v44, 0
    s_mov_b64 exec, 1
    global_store_dwordx4 v44, v[40:43], s[12:13]
    s_mov_b64 exec, -1
    s_nop 0
nohint_27:
    s_cmp_lt_u32 s8, 3
    s_cbranch_scc1 L_A_end
    s_bfe_u32 s62, s2, 0x20005
    s_lshl_b32 s62, s62, 3
    s_add_u32 s62, s62, s4
    s_bfe_u32 s63, s2, 0x20003
    s_sub_u32 s14, s8, 3
    s_min_u32 s51, s62, 26
    v_mul_u32_u24 v3, 5120, v2
    v_lshl_add_u32 v3, v1, 4, v3
    s_mul_i32 s10, s51, 81920
    s_mul_i32 s11, s63, 20480
    s_add_u32 s10, s10, s11
    s_lshl_b32 s11, s14, 8
    s_add_u32 s10, s10, s11
    s_add_u32 s12, s34, s10
    s_addc_u32 s13, s35, 0
    v_mov_b32 v80, 0
    v_mov_b32 v81, 0
    v_mov_b32 v82, 0
    v_mov_b32 v83, 0
    v_lshrrev_b32 v15, 5, v0
    v_mul_u32_u24 v15, 40, v15
    v_lshrrev_b32 v86, 1, v1
    v_add_u32 v15, v15, v86
    v_lshlrev_b32 v15, 14, v15
    v_and_b32 v86, 1, v0
    v_lshl_add_u32 v15, v86, 5, v15
    v_and_b32 v86, 1, v2
    v_lshl_add_u32 v15, v86, 4, v15
    s_lshl_b32 s10, s14, 17
    s_lshl_b32 s11, s2, 6
    s_add_u32 s10, s10, s11
    s_add_u32 s10, s10, 0x200000
    s_add_u32 s60, s42, s10
    s_addc_u32 s61, s43, 0
    s_cmp_ge_u32 s62, 27
    s_cbranch_scc1 L_A_st
    v_and_b32 v245, 7, v0
    v_lshlrev_b32 v245, 10, v245
    v_bfe_u32 v85, v0, 3, 1
    v_lshl_add_u32 v245, v85, 9, v245
    v_lshl_add_u32 v245, v2, 4, v245
    s_lshl_b32 s10, s62, 13
    s_lshl_b32 s11, s63, 6
    s_add_u32 s10, s10, s11
    s_add_u32 s10, s10, 0xc0000
    s_add_u32 s56, s42, s10
    s_addc_u32 s57, s43, 0
    global_load_dwordx4 v[88:91], v245, s[56:57] sc1
    global_load_dwordx4 v[92:95], v245, s[56:57] offset:256 sc1
    global_load_dwordx4 v[48:51], v3, s[12:13] offset:0 nt
    global_load_dwordx4 v[52:55], v3, s[12:13] offset:1280 nt
    global_load_dwordx4 v[56:59], v3, s[12:13] offset:2560 nt
    global_load_dwordx4 v[60:63], v3, s[12:13] offset:3840 nt
    v_mov_b32 v86, 0x20000
    ds_read_b64 v[126:127], v86
    v_and_b32 v211, 1, v0
    v_cmp_eq_u32 vcc, 1, v211
    v_mov_b32 v208, 0x0c0c0100
    v_mov_b32 v209, 0x01000c0c
    v_cndmask_b32 v208, v208, v209, vcc
    v_mov_b32 v209, 0x0c0c0302
    v_mov_b32 v210, 0x03020c0c
    v_cndmask_b32 v209, v209, v210, vcc
    v_bfe_u32 v211, v0, 1, 2
    v_mov_b32 v210, 0x0c0c0c0c
    v_cmp_eq_u32 vcc, 0, v211
    s_nop 1
    v_cndmask_b32 v4, v210, v208, vcc
    v_cndmask_b32 v8, v210, v209, vcc
    v_cmp_eq_u32 vcc, 1, v211
    s_nop 1
    v_cndmask_b32 v5, v210, v208, vcc
    v_cndmask_b32 v9, v210, v209, vcc
    v_cmp_eq_u32 vcc, 2, v211
    s_nop 1
    v_cndmask_b32 v6, v210, v208, vcc
    v_cndmask_b32 v10, v210, v209, vcc
    v_cmp_eq_u32 vcc, 3, v211
    s_nop 1
    v_cndmask_b32 v7, v210, v208, vcc
    v_cndmask_b32 v11, v210, v209, vcc
    s_waitcnt vmcnt(4)
    v_xor_b32 v86, s44, v88
    v_bitop3_b32 v86, v86, v89, s45 bitop3:0xf6
    v_bitop3_b32 v86, v86, v90, s46 bitop3:0xf6
    v_bitop3_b32 v86, v86, v91, s47 bitop3:0xf6
    v_bitop3_b32 v86, v86, v92, s44 bitop3:0xf6
    v_bitop3_b32 v86, v86, v93, s45 bitop3:0xf6
    v_bitop3_b32 v86, v86, v94, s46 bitop3:0xf6
    v_bitop3_b32 v86, v86, v95, s47 bitop3:0xf6
    v_and_b32 v86, s48, v86
    v_cmp_ne_u32 vcc, 0, v86
    s_cbranch_vccz L_A_hfok
    s_mov_b32 s49, 300000
    s_nop 2
poll_28:
    global_load_dwordx4 v[88:91], v245, s[56:57] sc1
    global_load_dwordx4 v[92:95], v245, s[56:57] offset:256 sc1
    s_waitcnt vmcnt(0)
    v_xor_b32 v86, s44, v88
    v_bitop3_b32 v86, v86, v89, s45 bitop3:0xf6
    v_bitop3_b32 v86, v86, v90, s46 bitop3:0xf6
    v_bitop3_b32 v86, v86, v91, s47 bitop3:0xf6
    v_bitop3_b32 v86, v86, v92, s44 bitop3:0xf6
    v_bitop3_b32 v86, v86, v93, s45 bitop3:0xf6
    v_bitop3_b32 v86, v86, v94, s46 bitop3:0xf6
    v_bitop3_b32 v86, v86, v95, s47 bitop3:0xf6
    v_and_b32 v86, s48, v86
    v_cmp_ne_u32 vcc, 0, v86
    s_cbranch_vccz pdone_29
    s_sub_u32 s49, s49, 1
    s_cbranch_scc1 pdone_29
    s_sleep 2
    s_branch poll_28
pdone_29:
L_A_hfok:
    s_waitcnt lgkmcnt(0)
    v_xor_b32 v88, s44, v88
    v_xor_b32 v92, s44, v92
    v_xor_b32 v89, s45, v89
    v_xor_b32 v93, s45, v93
    v_xor_b32 v90, s46, v90
    v_xor_b32 v94, s46, v94
    v_xor_b32 v91, s47, v91
    v_xor_b32 v95, s47, v95
    v_add_f32_dpp v88, v88, v88 quad_perm:[1,0,3,2] row_mask:0xf bank_mask:0xf
    v_add_f32_dpp v89, v89, v89 quad_perm:[1,0,3,2] row_mask:0xf bank_mask:0xf
    v_add_f32_dpp v90, v90, v90 quad_perm:[1,0,3,2] row_mask:0xf bank_mask:0xf
    v_add_f32_dpp v91, v91, v91 quad_perm:[1,0,3,2] row_mask:0xf bank_mask:0xf
    v_add_f32_dpp v92, v92, v92 quad_perm:[1,0,3,2] row_mask:0xf bank_mask:0xf
    v_add_f32_dpp v93, v93, v93 quad_perm:[1,0,3,2] row_mask:0xf bank_mask:0xf
    v_add_f32_dpp v94, v94, v94 quad_perm:[1,0,3,2] row_mask:0xf bank_mask:0xf
    v_add_f32_dpp v95, v95, v95 quad_perm:[1,0,3,2] row_mask:0xf bank_mask:0xf
    v_add_f32_dpp v88, v88, v88 quad_perm:[2,3,0,1] row_mask:0xf bank_mask:0xf
    v_add_f32_dpp v89, v89, v89 quad_perm:[2,3,0,1] row_mask:0xf bank_mask:0xf
    v_add_f32_dpp v90, v90, v90 quad_perm:[2,3,0,1] row_mask:0xf bank_mask:0xf
    v_add_f32_dpp v91, v91, v91 quad_perm:[2,3,0,1] row_mask:0xf bank_mask:0xf
    v_add_f32_dpp v92, v92, v92 quad_perm:[2,3,0,1] row_mask:0xf bank_mask:0xf
    v_add_f32_dpp v93, v93, v93 quad_perm:[2,3,0,1] row_mask:0xf bank_mask:0xf
    v_add_f32_dpp v94, v94, v94 quad_perm:[2,3,0,1] row_mask:0xf bank_mask:0xf
    v_add_f32_dpp v95, v95, v95 quad_perm:[2,3,0,1] row_mask:0xf bank_mask:0xf
    v_add_f32_dpp v88, v88, v88 row_half_mirror row_mask:0xf bank_mask:0xf
    v_add_f32_dpp v89, v89, v89 row_half_mirror row_mask:0xf bank_mask:0xf
    v_add_f32_dpp v90, v90, v90 row_half_mirror row_mask:0xf bank_mask:0xf
    v_add_f32_dpp v91, v91, v91 row_half_mirror row_mask:0xf bank_mask:0xf
    v_add_f32_dpp v92, v92, v92 row_half_mirror row_mask:0xf bank_mask:0xf
    v_add_f32_dpp v93, v93, v93 row_half_mirror row_mask:0xf bank_mask:0xf
    v_add_f32_dpp v94, v94, v94 row_half_mirror row_mask:0xf bank_mask:0xf
    v_add_f32_dpp v95, v95, v95 row_half_mirror row_mask:0xf bank_mask:0xf
    v_mov_b32 v86, v126
    v_mov_b32 v87, v127
    v_cmp_eq_u32 vcc, 1, v85
    s_nop 1
    v_cndmask_b32 v86, v86, v87, vcc
    v_sub_f32 v86, 1.0, v86
    v_mul_f32 v96, 0xbfb8aa3b, v88
    v_mul_f32 v97, 0xbfb8aa3b, v89
    v_mul_f32 v98, 0xbfb8aa3b, v90
    v_mul_f32 v99, 0xbfb8aa3b, v91
    v_exp_f32 v96, v96
    v_exp_f32 v97, v97
    v_exp_f32 v98, v98
    v_exp_f32 v99, v99
    v_add_f32 v96, 1.0, v96
    v_add_f32 v97, 1.0, v97
    v_add_f32 v98, 1.0, v98
    v_add_f32 v99, 1.0, v99
    v_rcp_f32 v96, v96
    v_rcp_f32 v97, v97
    v_rcp_f32 v98, v98
    v_rcp_f32 v99, v99
    v_mul_f32 v88, v88, v92
    v_mul_f32 v89, v89, v93
    v_mul_f32 v90, v90, v94
    v_mul_f32 v91, v91, v95
    v_mul_f32 v88, v88, v96
    v_mul_f32 v89, v89, v97
    v_mul_f32 v90, v90, v98
    v_mul_f32 v91, v91, v99
    v_mul_f32 v88, v88, v86
    v_mul_f32 v89, v89, v86
    v_mul_f32 v90, v90, v86
    v_mul_f32 v91, v91, v86
    v_cvt_pk_bf16_f32 v88, v88, v89
    v_cvt_pk_bf16_f32 v89, v90, v91
    v_perm_b32 v128, v88, v88, v4
    v_perm_b32 v129, v88, v88, v5
    v_perm_b32 v130, v88, v88, v6
    v_perm_b32 v131, v88, v88, v7
    v_perm_b32 v132, v88, v88, v8
    v_perm_b32 v133, v88, v88, v9
    v_perm_b32 v134, v88, v88, v10
    v_perm_b32 v135, v88, v88, v11
    v_perm_b32 v136, v89, v89, v4
    v_perm_b32 v137, v89, v89, v5
    v_perm_b32 v138, v89, v89, v6
    v_perm_b32 v139, v89, v89, v7
    v_perm_b32 v140, v89, v89, v8
    v_perm_b32 v141, v89, v89, v9
    v_perm_b32 v142, v89, v89, v10
    v_perm_b32 v143, v89, v89, v11
    s_waitcnt vmcnt(3)
    v_mfma_f32_16x16x32_bf16 v[80:83], v[128:131], v[48:51], 0
    s_waitcnt vmcnt(2)
    v_mfma_f32_16x16x32_bf16 v[80:83], v[132:135], v[52:55], v[80:83]
    s_waitcnt vmcnt(1)
    v_mfma_f32_16x16x32_bf16 v[80:83], v[136:139], v[56:59], v[80:83]
    s_waitcnt vmcnt(0)
    v_mfma_f32_16x16x32_bf16 v[80:83], v[140:143], v[60:63], v[80:83]
    s_nop 7
L_A_st:
    v_add_u32 v80, 0x800, v80
    v_add_u32 v81, 0x800, v81
    v_add_u32 v82, 0x800, v82
    v_add_u32 v83, 0x800, v83
    v_and_or_b32 v80, v80, v192, s44
    v_and_or_b32 v81, v81, v192, s45
    v_and_or_b32 v82, v82, v192, s46
    v_and_or_b32 v83, v83, v192, s47
    global_store_dwordx4 v15, v[80:83], s[60:61] sc1
    s_nop 1
L_A_end:
L_end:
    s_endpgm
.section .rodata,"a"
.p2align 6
.amdhsa_kernel gated_mix__compressed_kv_cla__swiglu_ffn__decode_kernel
  .amdhsa_next_free_vgpr 256
  .amdhsa_next_free_sgpr 102
  .amdhsa_accum_offset 256
  .amdhsa_group_segment_fixed_size 0
  .amdhsa_kernarg_size 112
  .amdhsa_user_sgpr_count 2
  .amdhsa_user_sgpr_kernarg_segment_ptr 1
  .amdhsa_system_sgpr_workgroup_id_x 1
.end_amdhsa_kernel
```
